```python
import torch

def _softmax(x, axis=-1):
    return torch.softmax(x, dim=axis)
def _gelu(x):
    return torch.nn.functional.gelu(x, approximate="tanh")
def _silu(x):
    return torch.nn.functional.silu(x)
def _sigmoid(x):
    return torch.sigmoid(x)
def _layernorm(x, axis=-1, eps=1e-5):
    m = x.mean(dim=axis, keepdim=True)
    v = x.var(dim=axis, keepdim=True, unbiased=False)
    return (x - m) / torch.sqrt(v + eps)
def _scatter_add(tgt, idx, src, axis=0):
    return tgt.clone().index_add_(axis, idx, src)
def _segment_sum(src, seg, n):
    out = torch.zeros((n,) + src.shape[1:], dtype=src.dtype)
    return out.index_add_(0, seg, src)
def _pad(x, pw):
    flat = tuple(v for pair in reversed(pw) for v in pair)
    return torch.nn.functional.pad(x, flat)

kernel_name = 'gated_mix__gqa_block_cached__glu_gated_glu__decode'

def setup_inputs():

    _w = (lambda a: (lambda t: t.to(torch.bfloat16) if t.is_floating_point() else t)(torch.as_tensor(a)))
    def _A_setup():
        B, Sq, D = 2, 1, 448
        Hq, Hkv, Sk, Dh = 16, 8, 16384, 256
        assert Hq % Hkv == 0, (Hq, Hkv)
        return {
            "x": _w((lambda *s: torch.randn(*s, dtype=torch.bfloat16) * 0.05)(B, Sq, D)),
            "k_cache": _w((lambda *s: torch.randn(*s, dtype=torch.bfloat16) * 6.4)(B, Hkv, Sk, Dh)),
            "v_cache": _w((lambda *s: torch.randn(*s, dtype=torch.bfloat16) * 0.4)(B, Hkv, Sk, Dh)),
            "wq": _w((lambda *s: torch.randn(*s, dtype=torch.bfloat16) * 6.4)(D, Hq * Dh) * (D ** -0.5)),
            "wo": _w((lambda *s: torch.randn(*s, dtype=torch.bfloat16) * 0.4)(Hq * Dh, D) * ((Hq * Dh) ** -0.5)),
        }
    _A_in = _A_setup()

    def _B_setup():
        B, S, D, F = 2, 1, 448, 1792
        return {
            "x": _w((lambda *s: torch.randn(*s, dtype=torch.bfloat16) * 0.05)(B, S, D)),
            "w_gate": _w((lambda *s: torch.randn(*s, dtype=torch.bfloat16) * 0.4)(D, F)),
            "w_up": _w((lambda *s: torch.randn(*s, dtype=torch.bfloat16) * 0.05)(D, F)),
            "w_down": _w((lambda *s: torch.randn(*s, dtype=torch.bfloat16) * 0.05)(F, D)),
        }
    _B_in = _B_setup()

    return {
        "A_x": _A_in["x"],
        "A_k_cache": _A_in["k_cache"],
        "A_v_cache": _A_in["v_cache"],
        "A_wq": _A_in["wq"],
        "A_wo": _A_in["wo"],
        "B_x": _B_in["x"],
        "B_w_gate": _B_in["w_gate"],
        "B_w_up": _B_in["w_up"],
        "B_w_down": _B_in["w_down"],
        "gate_w": _w((lambda *s: torch.randn(*s, dtype=torch.bfloat16) * 0.05)(448) * 16.0),
    }

def reference(A_x, A_k_cache, A_v_cache, A_wq, A_wo, B_x, B_w_gate, B_w_up, B_w_down, gate_w):
    def _A_ref(x, k_cache, v_cache, wq, wo):
        B, Sq, D = x.shape
        Hq, Dh = 16, 256
        Hkv = k_cache.shape[1]
        rep = Hq // Hkv
        q = (lambda x, *d: x.permute(*d))((x @ wq).reshape(B, Sq, Hq, Dh), 0, 2, 1, 3)
        k = (lambda x, n, axis: torch.repeat_interleave(x, n, dim=axis))(k_cache, rep, axis=1)
        v = (lambda x, n, axis: torch.repeat_interleave(x, n, dim=axis))(v_cache, rep, axis=1)
        scores = torch.einsum("bhqd,bhkd->bhqk", q, k) * (Dh ** -0.5)
        p = _softmax(scores, axis=-1)
        o = torch.einsum("bhqk,bhkd->bhqd", p, v)
        return (lambda x, *d: x.permute(*d))(o, 0, 2, 1, 3).reshape(B, Sq, Hq * Dh) @ wo

    def _B_ref(x, w_gate, w_up, w_down):
        g = torch.einsum("bsd,df->bsf", x, w_gate)
        u = torch.einsum("bsd,df->bsf", x, w_up)
        h = _sigmoid(g) * u
        return torch.einsum("bsf,fd->bsd", h, w_down)

    x = A_x
    g = _sigmoid((x * gate_w).sum(-1, keepdims=True))
    a = _A_ref(x, A_k_cache, A_v_cache, A_wq, A_wo)
    b = _B_ref(x, B_w_gate, B_w_up, B_w_down)
    return g * a + (1 - g) * b
```

```asm
; @launch grid=(256,1,1) block=(384,1,1) lds=65536
.amdgcn_target "amdgcn-amd-amdhsa--gfx950"
.text
.globl gated_mix__gqa_block_cached__glu_gated_glu__decode_kernel
.p2align 8
.type gated_mix__gqa_block_cached__glu_gated_glu__decode_kernel,@function
gated_mix__gqa_block_cached__glu_gated_glu__decode_kernel:
    s_cmp_ge_u32 s2, 256
    s_cbranch_scc1 L_end
    s_load_dwordx16 s[16:31], s[0:1], 0
    s_load_dwordx8 s[32:39], s[0:1], 64
    s_load_dwordx2 s[40:41], s[0:1], 96
    v_lshrrev_b32 v2, 6, v0
    v_and_b32 v1, 63, v0
    v_readfirstlane_b32 s3, v2
    s_and_b32 s6, s2, 7
    s_lshr_b32 s7, s2, 3
    s_lshr_b32 s8, s2, 7
    s_and_b32 s5, s7, 15
    s_mul_i32 s9, s7, 37
    s_lshr_b32 s9, s9, 8
    s_mul_i32 s10, s9, 7
    s_sub_u32 s10, s7, s10
    s_cmp_ge_u32 s3, 4
    s_cbranch_scc1 L_helpers
    s_lshl_b32 s4, s8, 3
    s_or_b32 s4, s4, s6
    s_lshl_b32 s13, s5, 2
    s_add_u32 s13, s13, s3
    s_lshl_b32 s11, s4, 23
    s_bfe_u32 s12, s13, 65536
    s_mul_i32 s12, s12, 1024
    s_xor_b32 s11, s11, s12
    s_bfe_u32 s12, s13, 65537
    s_mul_i32 s12, s12, 2048
    s_xor_b32 s11, s11, s12
    s_bfe_u32 s12, s13, 65538
    s_mul_i32 s12, s12, 4096
    s_xor_b32 s11, s11, s12
    s_bfe_u32 s12, s13, 65539
    s_mul_i32 s12, s12, 16384
    s_xor_b32 s11, s11, s12
    s_bfe_u32 s12, s13, 65540
    s_mul_i32 s12, s12, 262144
    s_xor_b32 s11, s11, s12
    s_bfe_u32 s12, s13, 65541
    s_mul_i32 s12, s12, 32768
    s_xor_b32 s11, s11, s12
    v_bfe_u32 v44, v1, 2, 1
    v_mul_u32_u24 v2, 512, v44
    v_bfe_u32 v44, v1, 3, 1
    v_mul_u32_u24 v44, 8192, v44
    v_xor_b32 v2, v2, v44
    v_lshrrev_b32 v45, 4, v1
    v_lshl_add_u32 v2, v45, 6, v2
    v_lshrrev_b32 v44, 5, v1
    v_lshl_add_u32 v2, v44, 7, v2
    v_and_b32 v44, 3, v1
    v_lshl_add_u32 v2, v44, 4, v2
    v_xor_b32 v2, s11, v2
    v_mov_b32 v252, v2
    v_lshrrev_b32 v3, 3, v1
    v_lshlrev_b32 v3, 13, v3
    v_and_b32 v4, 7, v1
    v_lshl_add_u32 v3, v4, 4, v3
    s_and_b32 s13, s7, 3
    s_mul_i32 s13, s13, 14
    s_add_u32 s13, s13, s3
    s_lshl_b32 s13, s13, 16
    s_lshl_b32 s12, s6, 3
    s_lshr_b32 s14, s7, 2
    s_add_u32 s12, s12, s14
    s_lshl_b32 s12, s12, 7
    s_add_u32 s13, s13, s12
    v_add_u32 v3, s13, v3
    s_lshl_b32 s13, s3, 10
    s_add_u32 m0, s13, 8192
    s_mov_b32 s54, 3670016
    s_mov_b32 s55, 0x20000
    s_mov_b32 s14, 262144
    s_mov_b32 s15, 524288
    s_mov_b32 s42, 786432
    v_lshlrev_b32 v4, 4, v1
    s_mov_b32 s50, 134217728
    s_mov_b32 s51, 0x20000
    s_mov_b32 s62, 1792
    s_mov_b32 s63, 0x20000
    s_waitcnt lgkmcnt(0)
    s_mov_b32 s52, s22
    s_and_b32 s53, s23, 0xffff
    buffer_load_dwordx4 v3, s[52:55], 0 offen nt lds
    s_add_u32 m0, s13, 12288
    s_mov_b32 s48, s18
    buffer_load_dwordx4 v3, s[52:55], s14 offen nt lds
    s_add_u32 m0, s13, 16384
    s_and_b32 s49, s19, 0xffff
    buffer_load_dwordx4 v3, s[52:55], s15 offen nt lds
    s_cmp_ge_u32 s3, 2
    s_cbranch_scc1 L_ldx
    s_add_u32 m0, s13, 20480
    s_nop 0
    buffer_load_dwordx4 v3, s[52:55], s42 offen nt lds
    s_branch L_ldx_done
L_ldx:
    s_sub_u32 s13, s13, 2048
    s_add_u32 m0, s13, 0
    s_mov_b32 s60, s16
    s_and_b32 s61, s17, 0xffff
    v_add_u32 v4, s13, v4
    buffer_load_dwordx4 v4, s[60:63], 0 offen lds
L_ldx_done:
    buffer_load_dwordx4 v[88:91], v252, s[48:51], 0 offen offset:0 nt
    buffer_load_dwordx4 v[92:95], v252, s[48:51], 0 offen offset:128 nt
    v_xor_b32 v252, 65536, v2
    s_and_b32 s74, s6, 1
    s_lshr_b32 s13, s6, 1
    s_mul_i32 s13, s13, 7
    s_mul_i32 s14, s74, 3
    s_add_u32 s13, s13, s14
    s_add_u32 s74, s74, 3
    s_lshr_b32 s14, s7, 3
    s_bitcmp1_b32 s7, 2
    s_cselect_b32 s68, s30, s28
    s_cselect_b32 s69, s31, s29
    s_and_b32 s69, s69, 0xffff
    s_mov_b32 s70, 1605632
    s_mov_b32 s71, 0x20000
    s_mov_b32 s76, s32
    s_and_b32 s77, s33, 0xffff
    s_mov_b32 s78, 1605632
    s_mov_b32 s79, 0x20000
    v_lshrrev_b32 v44, 3, v1
    v_mul_u32_u24 v253, 3584, v44
    v_mul_u32_u24 v254, 896, v44
    v_and_b32 v44, 7, v1
    v_lshl_add_u32 v253, v44, 4, v253
    v_lshl_add_u32 v254, v44, 4, v254
    s_and_b32 s42, s7, 3
    s_mul_i32 s42, s42, 14
    s_add_u32 s42, s42, s3
    s_mul_i32 s42, s42, 28672
    s_add_u32 s12, s13, s14
    s_lshl_b32 s12, s12, 7
    s_add_u32 s42, s42, s12
    s_cmp_lt_u32 s14, s74
    s_cselect_b32 s42, s42, 0x40000000
    v_add_u32 v253, s42, v253
    s_add_u32 s42, s13, s9
    s_lshl_b32 s42, s42, 3
    s_add_u32 s42, s42, s3
    s_mul_i32 s42, s42, 7168
    s_lshl_b32 s12, s10, 7
    s_add_u32 s42, s42, s12
    s_cmp_lt_u32 s9, s74
    s_cselect_b32 s42, s42, 0x40000000
    v_add_u32 v254, s42, v254
    s_lshl_b32 s72, s3, 10
    s_mov_b32 s73, 344064
    s_cmp_lt_u32 s3, 2
    s_cselect_b32 s73, s73, 0x20000000
    v_add_u32 v255, s73, v253
    s_add_u32 m0, s72, 24576
    s_mov_b32 s42, 0
    buffer_load_dwordx4 v253, s[68:71], s42 offen nt lds
    s_add_u32 m0, s72, 28672
    s_mov_b32 s42, 114688
    buffer_load_dwordx4 v253, s[68:71], s42 offen nt lds
    s_add_u32 m0, s72, 32768
    s_mov_b32 s42, 229376
    buffer_load_dwordx4 v253, s[68:71], s42 offen nt lds
    s_add_u32 m0, s72, 36864
    s_nop 0
    buffer_load_dwordx4 v255, s[68:71], 0 offen nt lds
    s_add_u32 m0, s72, 40960
    s_mov_b32 s42, 0
    buffer_load_dwordx4 v254, s[76:79], s42 offen nt lds
    s_add_u32 m0, s72, 45056
    s_mov_b32 s42, 28672
    buffer_load_dwordx4 v254, s[76:79], s42 offen nt lds
    s_mov_b32 s64, s20
    s_and_b32 s65, s21, 0xffff
    s_mov_b32 s66, 134217728
    s_mov_b32 s67, 0x20000
    s_mov_b32 s56, s40
    s_and_b32 s57, s41, 0xffff
    s_mov_b32 s58, 925696
    s_mov_b32 s59, 0x20000
    v_bfe_u32 v44, v1, 4, 1
    v_mul_u32_u24 v3, 512, v44
    v_bfe_u32 v44, v1, 5, 1
    v_mul_u32_u24 v44, 8192, v44
    v_xor_b32 v3, v3, v44
    v_and_b32 v44, 15, v1
    v_lshl_add_u32 v3, v44, 4, v3
    v_xor_b32 v3, s11, v3
    v_bfe_u32 v44, v1, 3, 1
    v_lshl_add_u32 v3, v44, 7, v3
    v_and_b32 v44, 1, v1
    v_lshlrev_b32 v44, 4, v44
    v_mov_b32 v45, 0xffff
    v_lshlrev_b32 v45, v44, v45
    v_bfe_u32 v44, v1, 1, 2
    v_cmp_eq_u32 vcc, 0, v44
    s_nop 1
    v_cndmask_b32 v4, 0, v45, vcc
    v_cmp_eq_u32 vcc, 1, v44
    s_nop 1
    v_cndmask_b32 v5, 0, v45, vcc
    v_cmp_eq_u32 vcc, 2, v44
    s_nop 1
    v_cndmask_b32 v6, 0, v45, vcc
    v_cmp_eq_u32 vcc, 3, v44
    s_nop 1
    v_cndmask_b32 v7, 0, v45, vcc
    v_mov_b32 v24, 0
    v_mov_b32 v25, 0
    v_mov_b32 v26, 0
    v_mov_b32 v27, 0
    v_mov_b32 v28, 0
    v_mov_b32 v29, 0
    v_mov_b32 v30, 0
    v_mov_b32 v31, 0
    v_mov_b32 v46, 0xff800000
    v_mov_b32 v47, 0
    v_bfe_u32 v44, v1, 3, 1
    v_lshlrev_b32 v80, 9, v44
    v_lshrrev_b32 v44, 4, v1
    v_lshl_add_u32 v80, v44, 6, v80
    v_lshrrev_b32 v44, 5, v1
    v_lshl_add_u32 v80, v44, 7, v80
    v_and_b32 v44, 3, v1
    v_lshl_add_u32 v80, v44, 4, v80
    s_lshl_b32 s13, s3, 12
    s_mov_b32 s43, 0x3db8aa3b
    s_lshl_b32 s11, s3, 2
    v_mov_b32 v248, s11
    v_mov_b32 v250, 0
    s_waitcnt vmcnt(8)
    s_barrier
    buffer_load_dwordx4 v[96:99], v252, s[48:51], 0 offen offset:0 nt
    buffer_load_dwordx4 v[100:103], v252, s[48:51], 0 offen offset:128 nt
    v_xor_b32 v252, 2097152, v2
    v_lshrrev_b32 v44, 5, v1
    v_lshlrev_b32 v82, 10, v44
    v_and_b32 v44, 15, v1
    v_lshl_add_u32 v82, v44, 5, v82
    v_bfe_u32 v44, v1, 3, 1
    v_lshl_add_u32 v82, v44, 8, v82
    v_bfe_u32 v44, v1, 4, 1
    v_lshl_add_u32 v82, v44, 4, v82
    s_lshl_b32 s11, s3, 11
    v_add_u32 v82, s11, v82
    s_lshl_b32 s11, s3, 9
    v_lshlrev_b32 v83, 3, v1
    v_add_u32 v83, s11, v83
    s_lshl_b32 s11, s6, 1
    s_add_u32 s11, s11, s8
    s_lshl_b32 s11, s11, 14
    s_add_u32 s11, s11, s13
    s_lshl_b32 s42, s5, 4
    s_add_u32 s11, s11, s42
    s_add_u32 s11, s11, 524288
    v_lshrrev_b32 v44, 4, v1
    v_lshlrev_b32 v84, 10, v44
    v_and_b32 v44, 15, v1
    v_lshl_add_u32 v84, v44, 6, v84
    v_add_u32 v84, s11, v84
    s_lshl_b32 s11, s6, 15
    s_lshl_b32 s42, s9, 12
    s_add_u32 s11, s11, s42
    s_and_b32 s12, s3, 1
    s_lshl_b32 s42, s12, 11
    s_add_u32 s11, s11, s42
    s_add_u32 s11, s11, 524288
    v_lshlrev_b32 v85, 4, v44
    v_lshrrev_b32 v44, 4, v1
    v_lshl_add_u32 v85, v44, 8, v85
    v_add_u32 v85, s11, v85
    v_lshlrev_b32 v86, 10, v44
    v_bfe_u32 v44, v1, 2, 2
    v_lshl_add_u32 v86, v44, 7, v86
    v_and_b32 v44, 3, v1
    v_lshl_add_u32 v86, v44, 3, v86
    s_lshl_b32 s11, s12, 13
    s_lshr_b32 s12, s3, 1
    s_lshl_b32 s12, s12, 6
    s_add_u32 s11, s11, s12
    v_add_u32 v86, s11, v86
    s_lshl_b32 s11, s3, 2
    v_lshl_add_u32 v87, v1, 4, s11
    s_mov_b32 s46, 0x11111111
    s_mov_b32 s47, 0x11111111
    s_mov_b32 s45, 0x4000
    v_mov_b32 v81, 0
    s_lshr_b32 s12, s3, 1
    s_lshl_b32 s11, s12, 8
    v_lshl_add_u32 v87, v1, 2, s11
    v_lshrrev_b32 v44, 5, v1
    v_and_b32 v45, 31, v1
    s_lshl_b32 s11, s12, 7
    v_lshl_add_u32 v253, v45, 2, s11
    v_lshl_add_u32 v253, v44, 8, v253
    s_lshl_b32 s42, s10, 1
    s_add_u32 s42, s42, s12
    s_lshl_b32 s11, s42, 6
    v_mul_u32_u24 v255, 896, v44
    v_lshl_add_u32 v255, v45, 1, v255
    v_add_u32 v255, s11, v255
    s_lshl_b32 s11, s42, 11
    s_add_u32 s11, s11, 32768
    v_and_b32 v45, 15, v1
    v_lshl_add_u32 v254, v45, 3, s11
    v_lshrrev_b32 v44, 4, v1
    v_lshl_add_u32 v254, v44, 8, v254
    s_mov_b32 s14, s42
    s_mov_b32 s60, s36
    s_and_b32 s61, s37, 0xffff
    s_mov_b32 s62, 1792
    s_mov_b32 s63, 0x20000
    s_mov_b32 s74, 0xaaaaaaaa
    s_mov_b32 s75, 0xaaaaaaaa
    buffer_load_dwordx4 v[104:107], v252, s[48:51], 0 offen offset:0 nt
    s_waitcnt vmcnt(10)
    buffer_load_dwordx4 v[108:111], v252, s[48:51], 0 offen offset:128 nt
    v_xor_b32 v252, 2162688, v2
    s_waitcnt vmcnt(10)
    buffer_load_dwordx4 v[112:115], v252, s[48:51], 0 offen offset:0 nt
    s_waitcnt vmcnt(4)
    buffer_load_dwordx4 v[116:119], v252, s[48:51], 0 offen offset:128 nt
    v_xor_b32 v252, 132096, v2
    s_waitcnt vmcnt(4)
    buffer_load_dwordx4 v[120:123], v252, s[48:51], 0 offen offset:0 nt
    s_waitcnt vmcnt(4)
    buffer_load_dwordx4 v[124:127], v252, s[48:51], 0 offen offset:128 nt
    v_xor_b32 v252, 197632, v2
    s_waitcnt vmcnt(4)
    buffer_load_dwordx4 v[128:131], v252, s[48:51], 0 offen offset:0 nt
    s_waitcnt vmcnt(4)
    buffer_load_dwordx4 v[132:135], v252, s[48:51], 0 offen offset:128 nt
    v_xor_b32 v252, 2229248, v2
    s_waitcnt vmcnt(4)
    buffer_load_dwordx4 v[136:139], v252, s[48:51], 0 offen offset:0 nt
    s_waitcnt vmcnt(4)
    buffer_load_dwordx4 v[140:143], v252, s[48:51], 0 offen offset:128 nt
    v_xor_b32 v252, 2294784, v2
    s_waitcnt vmcnt(4)
    buffer_load_dwordx4 v[144:147], v252, s[48:51], 0 offen offset:0 nt
    s_waitcnt vmcnt(4)
    buffer_load_dwordx4 v[148:151], v252, s[48:51], 0 offen offset:128 nt
    v_xor_b32 v252, 1052672, v2
    s_waitcnt vmcnt(4)
    buffer_load_dwordx4 v[152:155], v252, s[48:51], 0 offen offset:0 nt
    s_waitcnt vmcnt(4)
    buffer_load_dwordx4 v[156:159], v252, s[48:51], 0 offen offset:128 nt
    v_xor_b32 v252, 1118208, v2
    s_waitcnt vmcnt(4)
    buffer_load_dwordx4 v[160:163], v252, s[48:51], 0 offen offset:0 nt
    s_waitcnt vmcnt(4)
    buffer_load_dwordx4 v[164:167], v252, s[48:51], 0 offen offset:128 nt
    v_xor_b32 v252, 3149824, v2
    s_waitcnt vmcnt(4)
    buffer_load_dwordx4 v[168:171], v252, s[48:51], 0 offen offset:0 nt
    s_waitcnt vmcnt(4)
    buffer_load_dwordx4 v[172:175], v252, s[48:51], 0 offen offset:128 nt
    v_xor_b32 v252, 3215360, v2
    s_waitcnt lgkmcnt(0)
    v_cmp_lt_i32 vcc, 0, v250
    v_mov_b32 v249, 21
    ds_write_b32 v248, v249 offset:3296
    ds_read_b32 v250, v248 offset:3312
    s_waitcnt vmcnt(4)
    buffer_load_dwordx4 v[176:179], v252, s[48:51], 0 offen offset:0 nt
    s_waitcnt vmcnt(4)
    buffer_load_dwordx4 v[180:183], v252, s[48:51], 0 offen offset:128 nt
    v_xor_b32 v252, 1184768, v2
    s_waitcnt lgkmcnt(0)
    v_cmp_lt_i32 vcc, 0, v250
    v_mov_b32 v249, 23
    ds_write_b32 v248, v249 offset:3296
    ds_read_b32 v250, v248 offset:3312
    s_waitcnt vmcnt(4)
    buffer_load_dwordx4 v[184:187], v252, s[48:51], 0 offen offset:0 nt
    s_waitcnt vmcnt(4)
    buffer_load_dwordx4 v[188:191], v252, s[48:51], 0 offen offset:128 nt
    v_xor_b32 v252, 1250304, v2
    s_waitcnt lgkmcnt(0)
    v_cmp_lt_i32 vcc, 0, v250
    v_mov_b32 v249, 25
    ds_write_b32 v248, v249 offset:3296
    ds_read_b32 v250, v248 offset:3312
    s_waitcnt vmcnt(4)
    buffer_load_dwordx4 v[192:195], v252, s[48:51], 0 offen offset:0 nt
    s_waitcnt vmcnt(4)
    buffer_load_dwordx4 v[196:199], v252, s[48:51], 0 offen offset:128 nt
    v_xor_b32 v252, 3281920, v2
    s_waitcnt lgkmcnt(0)
    v_cmp_lt_i32 vcc, 0, v250
    v_mov_b32 v249, 27
    ds_write_b32 v248, v249 offset:3296
    ds_read_b32 v250, v248 offset:3312
    s_waitcnt vmcnt(4)
    buffer_load_dwordx4 v[200:203], v252, s[48:51], 0 offen offset:0 nt
    s_waitcnt vmcnt(4)
    buffer_load_dwordx4 v[204:207], v252, s[48:51], 0 offen offset:128 nt
    v_xor_b32 v252, 3347456, v2
    s_waitcnt lgkmcnt(0)
    v_cmp_lt_i32 vcc, 0, v250
    v_mov_b32 v249, 29
    ds_write_b32 v248, v249 offset:3296
    ds_read_b32 v250, v248 offset:3312
    s_waitcnt vmcnt(4)
    buffer_load_dwordx4 v[208:211], v252, s[48:51], 0 offen offset:0 nt
    s_waitcnt vmcnt(4)
    buffer_load_dwordx4 v[212:215], v252, s[48:51], 0 offen offset:128 nt
    v_xor_b32 v252, 541696, v2
    s_waitcnt lgkmcnt(0)
    v_cmp_lt_i32 vcc, 0, v250
    v_mov_b32 v249, 31
    ds_write_b32 v248, v249 offset:3296
    ds_read_b32 v250, v248 offset:3312
    s_cbranch_vccnz L_f32
    s_waitcnt vmcnt(4)
L_f32:
    buffer_load_dwordx4 v[216:219], v252, s[48:51], 0 offen offset:0 nt
    s_cbranch_vccnz L_f33
    s_waitcnt vmcnt(4)
L_f33:
    buffer_load_dwordx4 v[220:223], v252, s[48:51], 0 offen offset:128 nt
    v_xor_b32 v252, 607232, v2
    s_waitcnt lgkmcnt(0)
    v_cmp_lt_i32 vcc, 0, v250
    v_mov_b32 v249, 33
    ds_write_b32 v248, v249 offset:3296
    ds_read_b32 v250, v248 offset:3312
    s_cbranch_vccnz L_f34
    s_waitcnt vmcnt(4)
L_f34:
    s_waitcnt vmcnt(6)
    buffer_load_dwordx4 v[224:227], v252, s[48:51], 0 offen offset:0 nt
    s_cbranch_vccnz L_f35
    s_waitcnt vmcnt(4)
L_f35:
    s_waitcnt vmcnt(6)
    buffer_load_dwordx4 v[228:231], v252, s[48:51], 0 offen offset:128 nt
    v_xor_b32 v252, 2638848, v2
    s_waitcnt lgkmcnt(0)
    v_cmp_lt_i32 vcc, 0, v250
    v_mov_b32 v249, 35
    ds_write_b32 v248, v249 offset:3296
    ds_read_b32 v250, v248 offset:3312
    s_cbranch_vccnz L_f36
    s_waitcnt vmcnt(4)
L_f36:
    s_waitcnt vmcnt(6)
    buffer_load_dwordx4 v[232:235], v252, s[48:51], 0 offen offset:0 nt
    s_cbranch_vccnz L_f37
    s_waitcnt vmcnt(4)
L_f37:
    s_waitcnt vmcnt(6)
    buffer_load_dwordx4 v[236:239], v252, s[48:51], 0 offen offset:128 nt
    v_xor_b32 v252, 2704384, v2
    s_waitcnt lgkmcnt(0)
    v_cmp_lt_i32 vcc, 0, v250
    v_mov_b32 v249, 37
    ds_write_b32 v248, v249 offset:3296
    ds_read_b32 v250, v248 offset:3312
    s_cbranch_vccnz L_f38
    s_waitcnt vmcnt(4)
L_f38:
    s_waitcnt vmcnt(6)
    buffer_load_dwordx4 v[240:243], v252, s[48:51], 0 offen offset:0 nt
    s_cbranch_vccnz L_f39
    s_waitcnt vmcnt(4)
L_f39:
    s_waitcnt vmcnt(6)
    buffer_load_dwordx4 v[244:247], v252, s[48:51], 0 offen offset:128 nt
    v_xor_b32 v252, 671744, v2
    s_waitcnt lgkmcnt(0)
    v_cmp_lt_i32 vcc, 0, v250
    v_mov_b32 v249, 39
    ds_write_b32 v248, v249 offset:3296
    ds_read_b32 v250, v248 offset:3312
    s_cbranch_vccnz L_f40
    s_waitcnt vmcnt(4)
L_f40:
    s_waitcnt vmcnt(6)
    s_mov_b32 s11, 3200024
L_wait_q:
    ds_read_b96 v[32:34], v81 offset:3264
    ds_read_b128 v[8:11], v80 offset:2048
    ds_read_b128 v[12:15], v80 offset:2176
    s_sub_u32 s11, s11, 1
    s_cbranch_scc1 L_have_q
    s_waitcnt lgkmcnt(0)
    v_readfirstlane_b32 s15, v34
    s_cmp_eq_u32 s15, 0
    s_cbranch_scc1 L_wait_q
L_have_q:
    s_waitcnt lgkmcnt(0)
    v_and_b32 v44, 4, v1
    v_cmp_ne_u32 s[68:69], 0, v44
    v_readfirstlane_b32 s15, v32
    v_readfirstlane_b32 s12, v33
    s_lshr_b32 s11, s3, 1
    s_lshl_b32 s11, s11, 4
    v_mov_b32 v80, s11
    v_cndmask_b32 v16, 0, v8, s[68:69]
    v_cndmask_b32 v17, 0, v9, s[68:69]
    v_cndmask_b32 v18, 0, v10, s[68:69]
    v_cndmask_b32 v19, 0, v11, s[68:69]
    v_cndmask_b32 v20, 0, v12, s[68:69]
    v_cndmask_b32 v21, 0, v13, s[68:69]
    v_cndmask_b32 v22, 0, v14, s[68:69]
    v_cndmask_b32 v23, 0, v15, s[68:69]
    v_cndmask_b32 v8, v8, 0, s[68:69]
    v_cndmask_b32 v9, v9, 0, s[68:69]
    v_cndmask_b32 v10, v10, 0, s[68:69]
    v_cndmask_b32 v11, v11, 0, s[68:69]
    v_cndmask_b32 v12, v12, 0, s[68:69]
    v_cndmask_b32 v13, v13, 0, s[68:69]
    v_cndmask_b32 v14, v14, 0, s[68:69]
    v_cndmask_b32 v15, v15, 0, s[68:69]
    s_nop 1
    v_mfma_f32_16x16x32_bf16 v[32:35], v[88:91], v[8:11], 0
    v_mfma_f32_16x16x32_bf16 v[32:35], v[92:95], v[12:15], v[32:35]
    v_mfma_f32_16x16x32_bf16 v[32:35], v[96:99], v[16:19], v[32:35]
    v_mfma_f32_16x16x32_bf16 v[32:35], v[100:103], v[20:23], v[32:35]
    s_nop 7
    v_mov_b32_dpp v44, v32 quad_perm:[0,0,0,0] row_mask:0xf bank_mask:0xf
    v_mov_b32_dpp v45, v34 quad_perm:[2,2,2,2] row_mask:0xf bank_mask:0xf
    s_nop 0
    v_add_f32_dpp v44, v33, v44 quad_perm:[1,1,1,1] row_mask:0xf bank_mask:0xf
    v_add_f32_dpp v45, v35, v45 quad_perm:[3,3,3,3] row_mask:0xf bank_mask:0xf
    v_add_f32 v48, v44, v45
    v_max_f32 v46, v46, v48
    buffer_load_dwordx4 v[88:91], v252, s[48:51], 0 offen offset:0 nt
    v_mfma_f32_16x16x32_bf16 v[32:35], v[104:107], v[8:11], 0
    v_mfma_f32_16x16x32_bf16 v[32:35], v[108:111], v[12:15], v[32:35]
    v_mfma_f32_16x16x32_bf16 v[32:35], v[112:115], v[16:19], v[32:35]
    v_mfma_f32_16x16x32_bf16 v[32:35], v[116:119], v[20:23], v[32:35]
    s_nop 7
    v_mov_b32_dpp v44, v32 quad_perm:[0,0,0,0] row_mask:0xf bank_mask:0xf
    v_mov_b32_dpp v45, v34 quad_perm:[2,2,2,2] row_mask:0xf bank_mask:0xf
    s_nop 0
    v_add_f32_dpp v44, v33, v44 quad_perm:[1,1,1,1] row_mask:0xf bank_mask:0xf
    v_add_f32_dpp v45, v35, v45 quad_perm:[3,3,3,3] row_mask:0xf bank_mask:0xf
    v_add_f32 v49, v44, v45
    v_max_f32 v46, v46, v49
    s_cbranch_vccnz L_f41
    s_waitcnt vmcnt(4)
L_f41:
    s_waitcnt vmcnt(6)
    buffer_load_dwordx4 v[92:95], v252, s[48:51], 0 offen offset:128 nt
    v_xor_b32 v252, 737280, v2
    s_waitcnt lgkmcnt(0)
    v_cmp_lt_i32 vcc, 0, v250
    v_mov_b32 v249, 41
    ds_write_b32 v248, v249 offset:3296
    ds_read_b32 v250, v248 offset:3312
    v_mfma_f32_16x16x32_bf16 v[32:35], v[120:123], v[8:11], 0
    v_mfma_f32_16x16x32_bf16 v[32:35], v[124:127], v[12:15], v[32:35]
    v_mfma_f32_16x16x32_bf16 v[32:35], v[128:131], v[16:19], v[32:35]
    v_mfma_f32_16x16x32_bf16 v[32:35], v[132:135], v[20:23], v[32:35]
    s_nop 7
    v_mov_b32_dpp v44, v32 quad_perm:[0,0,0,0] row_mask:0xf bank_mask:0xf
    v_mov_b32_dpp v45, v34 quad_perm:[2,2,2,2] row_mask:0xf bank_mask:0xf
    s_nop 0
    v_add_f32_dpp v44, v33, v44 quad_perm:[1,1,1,1] row_mask:0xf bank_mask:0xf
    v_add_f32_dpp v45, v35, v45 quad_perm:[3,3,3,3] row_mask:0xf bank_mask:0xf
    v_add_f32 v50, v44, v45
    v_max_f32 v46, v46, v50
    s_cbranch_vccnz L_f42
    s_waitcnt vmcnt(4)
L_f42:
    s_waitcnt vmcnt(6)
    buffer_load_dwordx4 v[96:99], v252, s[48:51], 0 offen offset:0 nt
    v_mfma_f32_16x16x32_bf16 v[32:35], v[136:139], v[8:11], 0
    v_mfma_f32_16x16x32_bf16 v[32:35], v[140:143], v[12:15], v[32:35]
    v_mfma_f32_16x16x32_bf16 v[32:35], v[144:147], v[16:19], v[32:35]
    v_mfma_f32_16x16x32_bf16 v[32:35], v[148:151], v[20:23], v[32:35]
    s_nop 7
    v_mov_b32_dpp v44, v32 quad_perm:[0,0,0,0] row_mask:0xf bank_mask:0xf
    v_mov_b32_dpp v45, v34 quad_perm:[2,2,2,2] row_mask:0xf bank_mask:0xf
    s_nop 0
    v_add_f32_dpp v44, v33, v44 quad_perm:[1,1,1,1] row_mask:0xf bank_mask:0xf
    v_add_f32_dpp v45, v35, v45 quad_perm:[3,3,3,3] row_mask:0xf bank_mask:0xf
    v_add_f32 v51, v44, v45
    v_max_f32 v46, v46, v51
    s_cbranch_vccnz L_f43
    s_waitcnt vmcnt(4)
L_f43:
    s_waitcnt vmcnt(6)
    buffer_load_dwordx4 v[100:103], v252, s[48:51], 0 offen offset:128 nt
    v_xor_b32 v252, 2768896, v2
    s_waitcnt lgkmcnt(0)
    v_cmp_lt_i32 vcc, 0, v250
    v_mov_b32 v249, 43
    ds_write_b32 v248, v249 offset:3296
    ds_read_b32 v250, v248 offset:3312
    v_mfma_f32_16x16x32_bf16 v[32:35], v[152:155], v[8:11], 0
    v_mfma_f32_16x16x32_bf16 v[32:35], v[156:159], v[12:15], v[32:35]
    v_mfma_f32_16x16x32_bf16 v[32:35], v[160:163], v[16:19], v[32:35]
    v_mfma_f32_16x16x32_bf16 v[32:35], v[164:167], v[20:23], v[32:35]
    s_nop 7
    v_mov_b32_dpp v44, v32 quad_perm:[0,0,0,0] row_mask:0xf bank_mask:0xf
    v_mov_b32_dpp v45, v34 quad_perm:[2,2,2,2] row_mask:0xf bank_mask:0xf
    s_nop 0
    v_add_f32_dpp v44, v33, v44 quad_perm:[1,1,1,1] row_mask:0xf bank_mask:0xf
    v_add_f32_dpp v45, v35, v45 quad_perm:[3,3,3,3] row_mask:0xf bank_mask:0xf
    v_add_f32 v52, v44, v45
    v_max_f32 v46, v46, v52
    s_cbranch_vccnz L_f44
    s_waitcnt vmcnt(4)
L_f44:
    s_waitcnt vmcnt(6)
    buffer_load_dwordx4 v[104:107], v252, s[48:51], 0 offen offset:0 nt
    v_mfma_f32_16x16x32_bf16 v[32:35], v[168:171], v[8:11], 0
    v_mfma_f32_16x16x32_bf16 v[32:35], v[172:175], v[12:15], v[32:35]
    v_mfma_f32_16x16x32_bf16 v[32:35], v[176:179], v[16:19], v[32:35]
    v_mfma_f32_16x16x32_bf16 v[32:35], v[180:183], v[20:23], v[32:35]
    s_nop 7
    v_mov_b32_dpp v44, v32 quad_perm:[0,0,0,0] row_mask:0xf bank_mask:0xf
    v_mov_b32_dpp v45, v34 quad_perm:[2,2,2,2] row_mask:0xf bank_mask:0xf
    s_nop 0
    v_add_f32_dpp v44, v33, v44 quad_perm:[1,1,1,1] row_mask:0xf bank_mask:0xf
    v_add_f32_dpp v45, v35, v45 quad_perm:[3,3,3,3] row_mask:0xf bank_mask:0xf
    v_add_f32 v53, v44, v45
    v_max_f32 v46, v46, v53
    s_cbranch_vccnz L_f45
    s_waitcnt vmcnt(4)
L_f45:
    s_waitcnt vmcnt(6)
    buffer_load_dwordx4 v[108:111], v252, s[48:51], 0 offen offset:128 nt
    v_xor_b32 v252, 2834432, v2
    s_waitcnt lgkmcnt(0)
    v_cmp_lt_i32 vcc, 0, v250
    v_mov_b32 v249, 45
    ds_write_b32 v248, v249 offset:3296
    ds_read_b32 v250, v248 offset:3312
    v_mfma_f32_16x16x32_bf16 v[32:35], v[184:187], v[8:11], 0
    v_mfma_f32_16x16x32_bf16 v[32:35], v[188:191], v[12:15], v[32:35]
    v_mfma_f32_16x16x32_bf16 v[32:35], v[192:195], v[16:19], v[32:35]
    v_mfma_f32_16x16x32_bf16 v[32:35], v[196:199], v[20:23], v[32:35]
    s_nop 7
    v_mov_b32_dpp v44, v32 quad_perm:[0,0,0,0] row_mask:0xf bank_mask:0xf
    v_mov_b32_dpp v45, v34 quad_perm:[2,2,2,2] row_mask:0xf bank_mask:0xf
    s_nop 0
    v_add_f32_dpp v44, v33, v44 quad_perm:[1,1,1,1] row_mask:0xf bank_mask:0xf
    v_add_f32_dpp v45, v35, v45 quad_perm:[3,3,3,3] row_mask:0xf bank_mask:0xf
    v_add_f32 v54, v44, v45
    v_max_f32 v46, v46, v54
    s_cbranch_vccnz L_f46
    s_waitcnt vmcnt(4)
L_f46:
    s_waitcnt vmcnt(6)
    buffer_load_dwordx4 v[112:115], v252, s[48:51], 0 offen offset:0 nt
    v_mfma_f32_16x16x32_bf16 v[32:35], v[200:203], v[8:11], 0
    v_mfma_f32_16x16x32_bf16 v[32:35], v[204:207], v[12:15], v[32:35]
    v_mfma_f32_16x16x32_bf16 v[32:35], v[208:211], v[16:19], v[32:35]
    v_mfma_f32_16x16x32_bf16 v[32:35], v[212:215], v[20:23], v[32:35]
    s_nop 7
    v_mov_b32_dpp v44, v32 quad_perm:[0,0,0,0] row_mask:0xf bank_mask:0xf
    v_mov_b32_dpp v45, v34 quad_perm:[2,2,2,2] row_mask:0xf bank_mask:0xf
    s_nop 0
    v_add_f32_dpp v44, v33, v44 quad_perm:[1,1,1,1] row_mask:0xf bank_mask:0xf
    v_add_f32_dpp v45, v35, v45 quad_perm:[3,3,3,3] row_mask:0xf bank_mask:0xf
    v_add_f32 v55, v44, v45
    v_max_f32 v46, v46, v55
    s_cbranch_vccnz L_f47
    s_waitcnt vmcnt(4)
L_f47:
    s_waitcnt vmcnt(6)
    buffer_load_dwordx4 v[116:119], v252, s[48:51], 0 offen offset:128 nt
    v_xor_b32 v252, 1594368, v2
    s_waitcnt lgkmcnt(0)
    v_cmp_lt_i32 vcc, 0, v250
    v_mov_b32 v249, 47
    ds_write_b32 v248, v249 offset:3296
    ds_read_b32 v250, v248 offset:3312
    v_mfma_f32_16x16x32_bf16 v[32:35], v[216:219], v[8:11], 0
    v_mfma_f32_16x16x32_bf16 v[32:35], v[220:223], v[12:15], v[32:35]
    v_mfma_f32_16x16x32_bf16 v[32:35], v[224:227], v[16:19], v[32:35]
    v_mfma_f32_16x16x32_bf16 v[32:35], v[228:231], v[20:23], v[32:35]
    s_nop 7
    v_mov_b32_dpp v44, v32 quad_perm:[0,0,0,0] row_mask:0xf bank_mask:0xf
    v_mov_b32_dpp v45, v34 quad_perm:[2,2,2,2] row_mask:0xf bank_mask:0xf
    s_nop 0
    v_add_f32_dpp v44, v33, v44 quad_perm:[1,1,1,1] row_mask:0xf bank_mask:0xf
    v_add_f32_dpp v45, v35, v45 quad_perm:[3,3,3,3] row_mask:0xf bank_mask:0xf
    v_add_f32 v56, v44, v45
    v_max_f32 v46, v46, v56
    s_cbranch_vccnz L_f48
    s_waitcnt vmcnt(4)
L_f48:
    s_waitcnt vmcnt(6)
    buffer_load_dwordx4 v[120:123], v252, s[48:51], 0 offen offset:0 nt
    v_mfma_f32_16x16x32_bf16 v[32:35], v[232:235], v[8:11], 0
    v_mfma_f32_16x16x32_bf16 v[32:35], v[236:239], v[12:15], v[32:35]
    v_mfma_f32_16x16x32_bf16 v[32:35], v[240:243], v[16:19], v[32:35]
    v_mfma_f32_16x16x32_bf16 v[32:35], v[244:247], v[20:23], v[32:35]
    s_nop 7
    v_mov_b32_dpp v44, v32 quad_perm:[0,0,0,0] row_mask:0xf bank_mask:0xf
    v_mov_b32_dpp v45, v34 quad_perm:[2,2,2,2] row_mask:0xf bank_mask:0xf
    s_nop 0
    v_add_f32_dpp v44, v33, v44 quad_perm:[1,1,1,1] row_mask:0xf bank_mask:0xf
    v_add_f32_dpp v45, v35, v45 quad_perm:[3,3,3,3] row_mask:0xf bank_mask:0xf
    v_add_f32 v57, v44, v45
    v_max_f32 v46, v46, v57
    s_cbranch_vccnz L_f49
    s_waitcnt vmcnt(4)
L_f49:
    s_waitcnt vmcnt(6)
    buffer_load_dwordx4 v[124:127], v252, s[48:51], 0 offen offset:128 nt
    v_xor_b32 v252, 1659904, v2
    s_waitcnt lgkmcnt(0)
    v_cmp_lt_i32 vcc, 0, v250
    v_mov_b32 v249, 49
    ds_write_b32 v248, v249 offset:3296
    ds_read_b32 v250, v248 offset:3312
    s_cbranch_vccnz L_f50
    s_waitcnt vmcnt(4)
L_f50:
    s_waitcnt vmcnt(6)
    buffer_load_dwordx4 v[128:131], v252, s[48:51], 0 offen offset:0 nt
    v_mfma_f32_16x16x32_bf16 v[32:35], v[88:91], v[8:11], 0
    v_mfma_f32_16x16x32_bf16 v[32:35], v[92:95], v[12:15], v[32:35]
    v_mfma_f32_16x16x32_bf16 v[32:35], v[96:99], v[16:19], v[32:35]
    v_mfma_f32_16x16x32_bf16 v[32:35], v[100:103], v[20:23], v[32:35]
    s_nop 7
    v_mov_b32_dpp v44, v32 quad_perm:[0,0,0,0] row_mask:0xf bank_mask:0xf
    v_mov_b32_dpp v45, v34 quad_perm:[2,2,2,2] row_mask:0xf bank_mask:0xf
    s_nop 0
    v_add_f32_dpp v44, v33, v44 quad_perm:[1,1,1,1] row_mask:0xf bank_mask:0xf
    v_add_f32_dpp v45, v35, v45 quad_perm:[3,3,3,3] row_mask:0xf bank_mask:0xf
    v_add_f32 v58, v44, v45
    v_max_f32 v46, v46, v58
    s_cbranch_vccnz L_f51
    s_waitcnt vmcnt(4)
L_f51:
    s_waitcnt vmcnt(6)
    buffer_load_dwordx4 v[132:135], v252, s[48:51], 0 offen offset:128 nt
    v_xor_b32 v252, 3691520, v2
    s_waitcnt lgkmcnt(0)
    v_cmp_lt_i32 vcc, 0, v250
    v_mov_b32 v249, 51
    ds_write_b32 v248, v249 offset:3296
    ds_read_b32 v250, v248 offset:3312
    s_cbranch_vccnz L_f52
    s_waitcnt vmcnt(4)
L_f52:
    s_waitcnt vmcnt(6)
    buffer_load_dwordx4 v[136:139], v252, s[48:51], 0 offen offset:0 nt
    s_cbranch_vccnz L_f53
    s_waitcnt vmcnt(4)
L_f53:
    s_waitcnt vmcnt(6)
    buffer_load_dwordx4 v[140:143], v252, s[48:51], 0 offen offset:128 nt
    v_xor_b32 v252, 3757056, v2
    s_waitcnt lgkmcnt(0)
    v_cmp_lt_i32 vcc, 0, v250
    v_mov_b32 v249, 53
    ds_write_b32 v248, v249 offset:3296
    ds_read_b32 v250, v248 offset:3312
    s_cbranch_vccnz L_f54
    s_waitcnt vmcnt(4)
L_f54:
    s_waitcnt vmcnt(6)
    buffer_load_dwordx4 v[144:147], v252, s[48:51], 0 offen offset:0 nt
    v_mfma_f32_16x16x32_bf16 v[32:35], v[104:107], v[8:11], 0
    v_mfma_f32_16x16x32_bf16 v[32:35], v[108:111], v[12:15], v[32:35]
    v_mfma_f32_16x16x32_bf16 v[32:35], v[112:115], v[16:19], v[32:35]
    v_mfma_f32_16x16x32_bf16 v[32:35], v[116:119], v[20:23], v[32:35]
    s_nop 7
    v_mov_b32_dpp v44, v32 quad_perm:[0,0,0,0] row_mask:0xf bank_mask:0xf
    v_mov_b32_dpp v45, v34 quad_perm:[2,2,2,2] row_mask:0xf bank_mask:0xf
    s_nop 0
    v_add_f32_dpp v44, v33, v44 quad_perm:[1,1,1,1] row_mask:0xf bank_mask:0xf
    v_add_f32_dpp v45, v35, v45 quad_perm:[3,3,3,3] row_mask:0xf bank_mask:0xf
    v_add_f32 v59, v44, v45
    v_max_f32 v46, v46, v59
    s_cbranch_vccnz L_f55
    s_waitcnt vmcnt(4)
L_f55:
    s_waitcnt vmcnt(6)
    buffer_load_dwordx4 v[148:151], v252, s[48:51], 0 offen offset:128 nt
    v_xor_b32 v252, 1724416, v2
    s_waitcnt lgkmcnt(0)
    v_cmp_lt_i32 vcc, 0, v250
    v_mov_b32 v249, 55
    ds_write_b32 v248, v249 offset:3296
    ds_read_b32 v250, v248 offset:3312
    s_cbranch_vccnz L_f56
    s_waitcnt vmcnt(4)
L_f56:
    s_waitcnt vmcnt(6)
    buffer_load_dwordx4 v[152:155], v252, s[48:51], 0 offen offset:0 nt
    s_cbranch_vccnz L_f57
    s_waitcnt vmcnt(4)
L_f57:
    s_waitcnt vmcnt(6)
    buffer_load_dwordx4 v[156:159], v252, s[48:51], 0 offen offset:128 nt
    v_xor_b32 v252, 1789952, v2
    s_waitcnt lgkmcnt(0)
    v_cmp_lt_i32 vcc, 0, v250
    v_mov_b32 v249, 57
    ds_write_b32 v248, v249 offset:3296
    ds_read_b32 v250, v248 offset:3312
    s_cbranch_vccnz L_f58
    s_waitcnt vmcnt(4)
L_f58:
    s_waitcnt vmcnt(6)
    buffer_load_dwordx4 v[160:163], v252, s[48:51], 0 offen offset:0 nt
    v_mfma_f32_16x16x32_bf16 v[32:35], v[120:123], v[8:11], 0
    v_mfma_f32_16x16x32_bf16 v[32:35], v[124:127], v[12:15], v[32:35]
    v_mfma_f32_16x16x32_bf16 v[32:35], v[128:131], v[16:19], v[32:35]
    v_mfma_f32_16x16x32_bf16 v[32:35], v[132:135], v[20:23], v[32:35]
    s_nop 7
    v_mov_b32_dpp v44, v32 quad_perm:[0,0,0,0] row_mask:0xf bank_mask:0xf
    v_mov_b32_dpp v45, v34 quad_perm:[2,2,2,2] row_mask:0xf bank_mask:0xf
    s_nop 0
    v_add_f32_dpp v44, v33, v44 quad_perm:[1,1,1,1] row_mask:0xf bank_mask:0xf
    v_add_f32_dpp v45, v35, v45 quad_perm:[3,3,3,3] row_mask:0xf bank_mask:0xf
    v_add_f32 v60, v44, v45
    v_max_f32 v46, v46, v60
    s_cbranch_vccnz L_f59
    s_waitcnt vmcnt(4)
L_f59:
    s_waitcnt vmcnt(6)
    buffer_load_dwordx4 v[164:167], v252, s[48:51], 0 offen offset:128 nt
    v_xor_b32 v252, 3821568, v2
    s_waitcnt lgkmcnt(0)
    v_cmp_lt_i32 vcc, 0, v250
    v_mov_b32 v249, 59
    ds_write_b32 v248, v249 offset:3296
    ds_read_b32 v250, v248 offset:3312
    s_cbranch_vccnz L_f60
    s_waitcnt vmcnt(4)
L_f60:
    s_waitcnt vmcnt(6)
    buffer_load_dwordx4 v[168:171], v252, s[48:51], 0 offen offset:0 nt
    s_cbranch_vccnz L_f61
    s_waitcnt vmcnt(4)
L_f61:
    s_waitcnt vmcnt(6)
    buffer_load_dwordx4 v[172:175], v252, s[48:51], 0 offen offset:128 nt
    v_xor_b32 v252, 3887104, v2
    s_waitcnt lgkmcnt(0)
    v_cmp_lt_i32 vcc, 0, v250
    v_mov_b32 v249, 61
    ds_write_b32 v248, v249 offset:3296
    ds_read_b32 v250, v248 offset:3312
    s_cbranch_vccnz L_f62
    s_waitcnt vmcnt(4)
L_f62:
    s_waitcnt vmcnt(6)
    buffer_load_dwordx4 v[176:179], v252, s[48:51], 0 offen offset:0 nt
    v_mfma_f32_16x16x32_bf16 v[32:35], v[136:139], v[8:11], 0
    v_mfma_f32_16x16x32_bf16 v[32:35], v[140:143], v[12:15], v[32:35]
    v_mfma_f32_16x16x32_bf16 v[32:35], v[144:147], v[16:19], v[32:35]
    v_mfma_f32_16x16x32_bf16 v[32:35], v[148:151], v[20:23], v[32:35]
    s_nop 7
    v_mov_b32_dpp v44, v32 quad_perm:[0,0,0,0] row_mask:0xf bank_mask:0xf
    v_mov_b32_dpp v45, v34 quad_perm:[2,2,2,2] row_mask:0xf bank_mask:0xf
    s_nop 0
    v_add_f32_dpp v44, v33, v44 quad_perm:[1,1,1,1] row_mask:0xf bank_mask:0xf
    v_add_f32_dpp v45, v35, v45 quad_perm:[3,3,3,3] row_mask:0xf bank_mask:0xf
    v_add_f32 v61, v44, v45
    v_max_f32 v46, v46, v61
    s_cbranch_vccnz L_f63
    s_waitcnt vmcnt(4)
L_f63:
    s_waitcnt vmcnt(6)
    buffer_load_dwordx4 v[180:183], v252, s[48:51], 0 offen offset:128 nt
    v_xor_b32 v252, 4194304, v2
    s_waitcnt lgkmcnt(0)
    v_cmp_lt_i32 vcc, 0, v250
    v_mov_b32 v249, 63
    ds_write_b32 v248, v249 offset:3296
    ds_read_b32 v250, v248 offset:3312
    s_cbranch_vccnz L_f64
    s_waitcnt vmcnt(4)
L_f64:
    s_waitcnt vmcnt(6)
    buffer_load_dwordx4 v[184:187], v252, s[48:51], 0 offen offset:0 nt
    s_cbranch_vccnz L_f65
    s_waitcnt vmcnt(4)
L_f65:
    s_waitcnt vmcnt(6)
    buffer_load_dwordx4 v[188:191], v252, s[48:51], 0 offen offset:128 nt
    v_xor_b32 v252, 4259840, v2
    s_waitcnt lgkmcnt(0)
    v_cmp_lt_i32 vcc, 0, v250
    v_mov_b32 v249, 65
    ds_write_b32 v248, v249 offset:3296
    ds_read_b32 v250, v248 offset:3312
    s_cbranch_vccnz L_f66
    s_waitcnt vmcnt(4)
L_f66:
    s_waitcnt vmcnt(6)
    buffer_load_dwordx4 v[192:195], v252, s[48:51], 0 offen offset:0 nt
    v_mfma_f32_16x16x32_bf16 v[32:35], v[152:155], v[8:11], 0
    v_mfma_f32_16x16x32_bf16 v[32:35], v[156:159], v[12:15], v[32:35]
    v_mfma_f32_16x16x32_bf16 v[32:35], v[160:163], v[16:19], v[32:35]
    v_mfma_f32_16x16x32_bf16 v[32:35], v[164:167], v[20:23], v[32:35]
    s_nop 7
    v_mov_b32_dpp v44, v32 quad_perm:[0,0,0,0] row_mask:0xf bank_mask:0xf
    v_mov_b32_dpp v45, v34 quad_perm:[2,2,2,2] row_mask:0xf bank_mask:0xf
    s_nop 0
    v_add_f32_dpp v44, v33, v44 quad_perm:[1,1,1,1] row_mask:0xf bank_mask:0xf
    v_add_f32_dpp v45, v35, v45 quad_perm:[3,3,3,3] row_mask:0xf bank_mask:0xf
    v_add_f32 v62, v44, v45
    v_max_f32 v46, v46, v62
    s_cbranch_vccnz L_f67
    s_waitcnt vmcnt(4)
L_f67:
    s_waitcnt vmcnt(6)
    buffer_load_dwordx4 v[196:199], v252, s[48:51], 0 offen offset:128 nt
    v_xor_b32 v252, 6291456, v2
    s_waitcnt lgkmcnt(0)
    v_cmp_lt_i32 vcc, 0, v250
    v_mov_b32 v249, 67
    ds_write_b32 v248, v249 offset:3296
    ds_read_b32 v250, v248 offset:3312
    s_cbranch_vccnz L_f68
    s_waitcnt vmcnt(4)
L_f68:
    s_waitcnt vmcnt(6)
    buffer_load_dwordx4 v[200:203], v252, s[48:51], 0 offen offset:0 nt
    s_cbranch_vccnz L_f69
    s_waitcnt vmcnt(4)
L_f69:
    s_waitcnt vmcnt(6)
    buffer_load_dwordx4 v[204:207], v252, s[48:51], 0 offen offset:128 nt
    v_xor_b32 v252, 6356992, v2
    s_waitcnt lgkmcnt(0)
    v_cmp_lt_i32 vcc, 0, v250
    v_mov_b32 v249, 69
    ds_write_b32 v248, v249 offset:3296
    ds_read_b32 v250, v248 offset:3312
    s_cbranch_vccnz L_f70
    s_waitcnt vmcnt(4)
L_f70:
    s_waitcnt vmcnt(6)
    buffer_load_dwordx4 v[208:211], v252, s[48:51], 0 offen offset:0 nt
    v_mfma_f32_16x16x32_bf16 v[32:35], v[168:171], v[8:11], 0
    v_mfma_f32_16x16x32_bf16 v[32:35], v[172:175], v[12:15], v[32:35]
    v_mfma_f32_16x16x32_bf16 v[32:35], v[176:179], v[16:19], v[32:35]
    v_mfma_f32_16x16x32_bf16 v[32:35], v[180:183], v[20:23], v[32:35]
    s_nop 7
    v_mov_b32_dpp v44, v32 quad_perm:[0,0,0,0] row_mask:0xf bank_mask:0xf
    v_mov_b32_dpp v45, v34 quad_perm:[2,2,2,2] row_mask:0xf bank_mask:0xf
    s_nop 0
    v_add_f32_dpp v44, v33, v44 quad_perm:[1,1,1,1] row_mask:0xf bank_mask:0xf
    v_add_f32_dpp v45, v35, v45 quad_perm:[3,3,3,3] row_mask:0xf bank_mask:0xf
    v_add_f32 v63, v44, v45
    v_max_f32 v46, v46, v63
    s_cbranch_vccnz L_f71
    s_waitcnt vmcnt(4)
L_f71:
    s_waitcnt vmcnt(6)
    buffer_load_dwordx4 v[212:215], v252, s[48:51], 0 offen offset:128 nt
    v_xor_b32 v252, 4326400, v2
    s_waitcnt lgkmcnt(0)
    v_cmp_lt_i32 vcc, 0, v250
    v_mov_b32 v249, 71
    ds_write_b32 v248, v249 offset:3296
    ds_read_b32 v250, v248 offset:3312
    s_cbranch_vccnz L_f72
    s_waitcnt vmcnt(4)
L_f72:
    s_waitcnt vmcnt(6)
    buffer_load_dwordx4 v[216:219], v252, s[48:51], 0 offen offset:0 nt
    s_cbranch_vccnz L_f73
    s_waitcnt vmcnt(4)
L_f73:
    s_waitcnt vmcnt(6)
    buffer_load_dwordx4 v[220:223], v252, s[48:51], 0 offen offset:128 nt
    v_xor_b32 v252, 4391936, v2
    s_waitcnt lgkmcnt(0)
    v_cmp_lt_i32 vcc, 0, v250
    v_mov_b32 v249, 73
    ds_write_b32 v248, v249 offset:3296
    ds_read_b32 v250, v248 offset:3312
    s_cbranch_vccnz L_f74
    s_waitcnt vmcnt(4)
L_f74:
    s_waitcnt vmcnt(6)
    buffer_load_dwordx4 v[224:227], v252, s[48:51], 0 offen offset:0 nt
    v_mfma_f32_16x16x32_bf16 v[32:35], v[184:187], v[8:11], 0
    v_mfma_f32_16x16x32_bf16 v[32:35], v[188:191], v[12:15], v[32:35]
    v_mfma_f32_16x16x32_bf16 v[32:35], v[192:195], v[16:19], v[32:35]
    v_mfma_f32_16x16x32_bf16 v[32:35], v[196:199], v[20:23], v[32:35]
    s_nop 7
    v_mov_b32_dpp v44, v32 quad_perm:[0,0,0,0] row_mask:0xf bank_mask:0xf
    v_mov_b32_dpp v45, v34 quad_perm:[2,2,2,2] row_mask:0xf bank_mask:0xf
    s_nop 0
    v_add_f32_dpp v44, v33, v44 quad_perm:[1,1,1,1] row_mask:0xf bank_mask:0xf
    v_add_f32_dpp v45, v35, v45 quad_perm:[3,3,3,3] row_mask:0xf bank_mask:0xf
    v_add_f32 v64, v44, v45
    v_max_f32 v46, v46, v64
    s_cbranch_vccnz L_f75
    s_waitcnt vmcnt(4)
L_f75:
    s_waitcnt vmcnt(6)
    buffer_load_dwordx4 v[228:231], v252, s[48:51], 0 offen offset:128 nt
    v_xor_b32 v252, 6423552, v2
    s_waitcnt lgkmcnt(0)
    v_cmp_lt_i32 vcc, 0, v250
    v_mov_b32 v249, 75
    ds_write_b32 v248, v249 offset:3296
    ds_read_b32 v250, v248 offset:3312
    s_cbranch_vccnz L_f76
    s_waitcnt vmcnt(4)
L_f76:
    s_waitcnt vmcnt(6)
    buffer_load_dwordx4 v[232:235], v252, s[48:51], 0 offen offset:0 nt
    s_cbranch_vccnz L_f77
    s_waitcnt vmcnt(4)
L_f77:
    s_waitcnt vmcnt(6)
    buffer_load_dwordx4 v[236:239], v252, s[48:51], 0 offen offset:128 nt
    v_xor_b32 v252, 6489088, v2
    s_waitcnt lgkmcnt(0)
    v_cmp_lt_i32 vcc, 0, v250
    v_mov_b32 v249, 77
    ds_write_b32 v248, v249 offset:3296
    ds_read_b32 v250, v248 offset:3312
    s_cbranch_vccnz L_f78
    s_waitcnt vmcnt(4)
L_f78:
    s_waitcnt vmcnt(6)
    buffer_load_dwordx4 v[240:243], v252, s[48:51], 0 offen offset:0 nt
    v_mfma_f32_16x16x32_bf16 v[32:35], v[200:203], v[8:11], 0
    v_mfma_f32_16x16x32_bf16 v[32:35], v[204:207], v[12:15], v[32:35]
    v_mfma_f32_16x16x32_bf16 v[32:35], v[208:211], v[16:19], v[32:35]
    v_mfma_f32_16x16x32_bf16 v[32:35], v[212:215], v[20:23], v[32:35]
    s_nop 7
    v_mov_b32_dpp v44, v32 quad_perm:[0,0,0,0] row_mask:0xf bank_mask:0xf
    v_mov_b32_dpp v45, v34 quad_perm:[2,2,2,2] row_mask:0xf bank_mask:0xf
    s_nop 0
    v_add_f32_dpp v44, v33, v44 quad_perm:[1,1,1,1] row_mask:0xf bank_mask:0xf
    v_add_f32_dpp v45, v35, v45 quad_perm:[3,3,3,3] row_mask:0xf bank_mask:0xf
    v_add_f32 v65, v44, v45
    v_max_f32 v46, v46, v65
    s_cbranch_vccnz L_f79
    s_waitcnt vmcnt(4)
L_f79:
    s_waitcnt vmcnt(6)
    buffer_load_dwordx4 v[244:247], v252, s[48:51], 0 offen offset:128 nt
    v_xor_b32 v252, 5246976, v2
    s_waitcnt lgkmcnt(0)
    v_cmp_lt_i32 vcc, 0, v250
    v_mov_b32 v249, 79
    ds_write_b32 v248, v249 offset:3296
    ds_read_b32 v250, v248 offset:3312
    s_cbranch_vccnz L_f80
    s_waitcnt vmcnt(4)
L_f80:
    s_waitcnt vmcnt(6)
    buffer_load_dwordx4 v[88:91], v252, s[48:51], 0 offen offset:0 nt
    s_cbranch_vccnz L_f81
    s_waitcnt vmcnt(4)
L_f81:
    s_waitcnt vmcnt(6)
    buffer_load_dwordx4 v[92:95], v252, s[48:51], 0 offen offset:128 nt
    v_xor_b32 v252, 5312512, v2
    s_waitcnt lgkmcnt(0)
    v_cmp_lt_i32 vcc, 0, v250
    v_mov_b32 v249, 81
    ds_write_b32 v248, v249 offset:3296
    ds_read_b32 v250, v248 offset:3312
    s_cbranch_vccnz L_f82
    s_waitcnt vmcnt(4)
L_f82:
    s_waitcnt vmcnt(6)
    buffer_load_dwordx4 v[96:99], v252, s[48:51], 0 offen offset:0 nt
    v_mfma_f32_16x16x32_bf16 v[32:35], v[216:219], v[8:11], 0
    v_mfma_f32_16x16x32_bf16 v[32:35], v[220:223], v[12:15], v[32:35]
    v_mfma_f32_16x16x32_bf16 v[32:35], v[224:227], v[16:19], v[32:35]
    v_mfma_f32_16x16x32_bf16 v[32:35], v[228:231], v[20:23], v[32:35]
    s_nop 7
    v_mov_b32_dpp v44, v32 quad_perm:[0,0,0,0] row_mask:0xf bank_mask:0xf
    v_mov_b32_dpp v45, v34 quad_perm:[2,2,2,2] row_mask:0xf bank_mask:0xf
    s_nop 0
    v_add_f32_dpp v44, v33, v44 quad_perm:[1,1,1,1] row_mask:0xf bank_mask:0xf
    v_add_f32_dpp v45, v35, v45 quad_perm:[3,3,3,3] row_mask:0xf bank_mask:0xf
    v_add_f32 v66, v44, v45
    v_max_f32 v46, v46, v66
    s_cbranch_vccnz L_f83
    s_waitcnt vmcnt(4)
L_f83:
    s_waitcnt vmcnt(6)
    buffer_load_dwordx4 v[100:103], v252, s[48:51], 0 offen offset:128 nt
    v_xor_b32 v252, 7344128, v2
    s_waitcnt lgkmcnt(0)
    v_cmp_lt_i32 vcc, 0, v250
    v_mov_b32 v249, 83
    ds_write_b32 v248, v249 offset:3296
    ds_read_b32 v250, v248 offset:3312
    s_cbranch_vccnz L_f84
    s_waitcnt vmcnt(4)
L_f84:
    s_waitcnt vmcnt(6)
    buffer_load_dwordx4 v[104:107], v252, s[48:51], 0 offen offset:0 nt
    s_cbranch_vccnz L_f85
    s_waitcnt vmcnt(4)
L_f85:
    s_waitcnt vmcnt(6)
    buffer_load_dwordx4 v[108:111], v252, s[48:51], 0 offen offset:128 nt
    v_xor_b32 v252, 7409664, v2
    s_waitcnt lgkmcnt(0)
    v_cmp_lt_i32 vcc, 0, v250
    v_mov_b32 v249, 85
    ds_write_b32 v248, v249 offset:3296
    ds_read_b32 v250, v248 offset:3312
    s_cbranch_vccnz L_f86
    s_waitcnt vmcnt(4)
L_f86:
    s_waitcnt vmcnt(6)
    buffer_load_dwordx4 v[112:115], v252, s[48:51], 0 offen offset:0 nt
    v_mfma_f32_16x16x32_bf16 v[32:35], v[232:235], v[8:11], 0
    v_mfma_f32_16x16x32_bf16 v[32:35], v[236:239], v[12:15], v[32:35]
    v_mfma_f32_16x16x32_bf16 v[32:35], v[240:243], v[16:19], v[32:35]
    v_mfma_f32_16x16x32_bf16 v[32:35], v[244:247], v[20:23], v[32:35]
    s_nop 7
    v_mov_b32_dpp v44, v32 quad_perm:[0,0,0,0] row_mask:0xf bank_mask:0xf
    v_mov_b32_dpp v45, v34 quad_perm:[2,2,2,2] row_mask:0xf bank_mask:0xf
    s_nop 0
    v_add_f32_dpp v44, v33, v44 quad_perm:[1,1,1,1] row_mask:0xf bank_mask:0xf
    v_add_f32_dpp v45, v35, v45 quad_perm:[3,3,3,3] row_mask:0xf bank_mask:0xf
    v_add_f32 v67, v44, v45
    v_max_f32 v46, v46, v67
    s_cbranch_vccnz L_f87
    s_waitcnt vmcnt(4)
L_f87:
    s_waitcnt vmcnt(6)
    buffer_load_dwordx4 v[116:119], v252, s[48:51], 0 offen offset:128 nt
    v_xor_b32 v252, 5379072, v2
    s_waitcnt lgkmcnt(0)
    v_cmp_lt_i32 vcc, 0, v250
    v_mov_b32 v249, 87
    ds_write_b32 v248, v249 offset:3296
    ds_read_b32 v250, v248 offset:3312
    s_cbranch_vccnz L_f88
    s_waitcnt vmcnt(4)
L_f88:
    s_waitcnt vmcnt(6)
    buffer_load_dwordx4 v[120:123], v252, s[48:51], 0 offen offset:0 nt
    s_cbranch_vccnz L_f89
    s_waitcnt vmcnt(4)
L_f89:
    s_waitcnt vmcnt(6)
    buffer_load_dwordx4 v[124:127], v252, s[48:51], 0 offen offset:128 nt
    v_xor_b32 v252, 5444608, v2
    s_waitcnt lgkmcnt(0)
    v_cmp_lt_i32 vcc, 0, v250
    v_mov_b32 v249, 89
    ds_write_b32 v248, v249 offset:3296
    ds_read_b32 v250, v248 offset:3312
    s_cbranch_vccnz L_f90
    s_waitcnt vmcnt(4)
L_f90:
    s_waitcnt vmcnt(6)
    buffer_load_dwordx4 v[128:131], v252, s[48:51], 0 offen offset:0 nt
    v_mfma_f32_16x16x32_bf16 v[32:35], v[88:91], v[8:11], 0
    v_mfma_f32_16x16x32_bf16 v[32:35], v[92:95], v[12:15], v[32:35]
    v_mfma_f32_16x16x32_bf16 v[32:35], v[96:99], v[16:19], v[32:35]
    v_mfma_f32_16x16x32_bf16 v[32:35], v[100:103], v[20:23], v[32:35]
    s_nop 7
    v_mov_b32_dpp v44, v32 quad_perm:[0,0,0,0] row_mask:0xf bank_mask:0xf
    v_mov_b32_dpp v45, v34 quad_perm:[2,2,2,2] row_mask:0xf bank_mask:0xf
    s_nop 0
    v_add_f32_dpp v44, v33, v44 quad_perm:[1,1,1,1] row_mask:0xf bank_mask:0xf
    v_add_f32_dpp v45, v35, v45 quad_perm:[3,3,3,3] row_mask:0xf bank_mask:0xf
    v_add_f32 v68, v44, v45
    v_max_f32 v46, v46, v68
    s_cbranch_vccnz L_f91
    s_waitcnt vmcnt(4)
L_f91:
    s_waitcnt vmcnt(6)
    buffer_load_dwordx4 v[132:135], v252, s[48:51], 0 offen offset:128 nt
    v_xor_b32 v252, 7476224, v2
    s_waitcnt lgkmcnt(0)
    v_cmp_lt_i32 vcc, 0, v250
    v_mov_b32 v249, 91
    ds_write_b32 v248, v249 offset:3296
    ds_read_b32 v250, v248 offset:3312
    s_cbranch_vccnz L_f92
    s_waitcnt vmcnt(4)
L_f92:
    s_waitcnt vmcnt(6)
    buffer_load_dwordx4 v[136:139], v252, s[48:51], 0 offen offset:0 nt
    s_cbranch_vccnz L_f93
    s_waitcnt vmcnt(4)
L_f93:
    s_waitcnt vmcnt(6)
    buffer_load_dwordx4 v[140:143], v252, s[48:51], 0 offen offset:128 nt
    v_xor_b32 v252, 7541760, v2
    s_waitcnt lgkmcnt(0)
    v_cmp_lt_i32 vcc, 0, v250
    v_mov_b32 v249, 93
    ds_write_b32 v248, v249 offset:3296
    ds_read_b32 v250, v248 offset:3312
    s_cbranch_vccnz L_f94
    s_waitcnt vmcnt(4)
L_f94:
    s_waitcnt vmcnt(6)
    buffer_load_dwordx4 v[144:147], v252, s[48:51], 0 offen offset:0 nt
    v_mfma_f32_16x16x32_bf16 v[32:35], v[104:107], v[8:11], 0
    v_mfma_f32_16x16x32_bf16 v[32:35], v[108:111], v[12:15], v[32:35]
    v_mfma_f32_16x16x32_bf16 v[32:35], v[112:115], v[16:19], v[32:35]
    v_mfma_f32_16x16x32_bf16 v[32:35], v[116:119], v[20:23], v[32:35]
    s_nop 7
    v_mov_b32_dpp v44, v32 quad_perm:[0,0,0,0] row_mask:0xf bank_mask:0xf
    v_mov_b32_dpp v45, v34 quad_perm:[2,2,2,2] row_mask:0xf bank_mask:0xf
    s_nop 0
    v_add_f32_dpp v44, v33, v44 quad_perm:[1,1,1,1] row_mask:0xf bank_mask:0xf
    v_add_f32_dpp v45, v35, v45 quad_perm:[3,3,3,3] row_mask:0xf bank_mask:0xf
    v_add_f32 v69, v44, v45
    v_max_f32 v46, v46, v69
    s_cbranch_vccnz L_f95
    s_waitcnt vmcnt(4)
L_f95:
    s_waitcnt vmcnt(6)
    buffer_load_dwordx4 v[148:151], v252, s[48:51], 0 offen offset:128 nt
    v_xor_b32 v252, 4736000, v2
    s_waitcnt lgkmcnt(0)
    v_cmp_lt_i32 vcc, 0, v250
    v_mov_b32 v249, 95
    ds_write_b32 v248, v249 offset:3296
    ds_read_b32 v250, v248 offset:3312
    s_cbranch_vccnz L_f96
    s_waitcnt vmcnt(4)
L_f96:
    s_waitcnt vmcnt(6)
    buffer_load_dwordx4 v[152:155], v252, s[48:51], 0 offen offset:0 nt
    s_cbranch_vccnz L_f97
    s_waitcnt vmcnt(4)
L_f97:
    s_waitcnt vmcnt(6)
    buffer_load_dwordx4 v[156:159], v252, s[48:51], 0 offen offset:128 nt
    v_xor_b32 v252, 4801536, v2
    s_waitcnt lgkmcnt(0)
    v_cmp_lt_i32 vcc, 0, v250
    v_mov_b32 v249, 97
    ds_write_b32 v248, v249 offset:3296
    ds_read_b32 v250, v248 offset:3312
    s_cbranch_vccnz L_f98
    s_waitcnt vmcnt(4)
L_f98:
    s_waitcnt vmcnt(6)
    buffer_load_dwordx4 v[160:163], v252, s[48:51], 0 offen offset:0 nt
    v_mfma_f32_16x16x32_bf16 v[32:35], v[120:123], v[8:11], 0
    v_mfma_f32_16x16x32_bf16 v[32:35], v[124:127], v[12:15], v[32:35]
    v_mfma_f32_16x16x32_bf16 v[32:35], v[128:131], v[16:19], v[32:35]
    v_mfma_f32_16x16x32_bf16 v[32:35], v[132:135], v[20:23], v[32:35]
    s_nop 7
    v_mov_b32_dpp v44, v32 quad_perm:[0,0,0,0] row_mask:0xf bank_mask:0xf
    v_mov_b32_dpp v45, v34 quad_perm:[2,2,2,2] row_mask:0xf bank_mask:0xf
    s_nop 0
    v_add_f32_dpp v44, v33, v44 quad_perm:[1,1,1,1] row_mask:0xf bank_mask:0xf
    v_add_f32_dpp v45, v35, v45 quad_perm:[3,3,3,3] row_mask:0xf bank_mask:0xf
    v_add_f32 v70, v44, v45
    v_max_f32 v46, v46, v70
    s_cbranch_vccnz L_f99
    s_waitcnt vmcnt(4)
L_f99:
    s_waitcnt vmcnt(6)
    buffer_load_dwordx4 v[164:167], v252, s[48:51], 0 offen offset:128 nt
    v_xor_b32 v252, 6833152, v2
    s_waitcnt lgkmcnt(0)
    v_cmp_lt_i32 vcc, 0, v250
    v_mov_b32 v249, 99
    ds_write_b32 v248, v249 offset:3296
    ds_read_b32 v250, v248 offset:3312
    s_cbranch_vccnz L_f100
    s_waitcnt vmcnt(4)
L_f100:
    s_waitcnt vmcnt(6)
    buffer_load_dwordx4 v[168:171], v252, s[48:51], 0 offen offset:0 nt
    s_cbranch_vccnz L_f101
    s_waitcnt vmcnt(4)
L_f101:
    s_waitcnt vmcnt(6)
    buffer_load_dwordx4 v[172:175], v252, s[48:51], 0 offen offset:128 nt
    v_xor_b32 v252, 6898688, v2
    s_waitcnt lgkmcnt(0)
    v_cmp_lt_i32 vcc, 0, v250
    v_mov_b32 v249, 101
    ds_write_b32 v248, v249 offset:3296
    ds_read_b32 v250, v248 offset:3312
    s_cbranch_vccnz L_f102
    s_waitcnt vmcnt(4)
L_f102:
    s_waitcnt vmcnt(6)
    buffer_load_dwordx4 v[176:179], v252, s[48:51], 0 offen offset:0 nt
    v_mfma_f32_16x16x32_bf16 v[32:35], v[136:139], v[8:11], 0
    v_mfma_f32_16x16x32_bf16 v[32:35], v[140:143], v[12:15], v[32:35]
    v_mfma_f32_16x16x32_bf16 v[32:35], v[144:147], v[16:19], v[32:35]
    v_mfma_f32_16x16x32_bf16 v[32:35], v[148:151], v[20:23], v[32:35]
    s_nop 7
    v_mov_b32_dpp v44, v32 quad_perm:[0,0,0,0] row_mask:0xf bank_mask:0xf
    v_mov_b32_dpp v45, v34 quad_perm:[2,2,2,2] row_mask:0xf bank_mask:0xf
    s_nop 0
    v_add_f32_dpp v44, v33, v44 quad_perm:[1,1,1,1] row_mask:0xf bank_mask:0xf
    v_add_f32_dpp v45, v35, v45 quad_perm:[3,3,3,3] row_mask:0xf bank_mask:0xf
    v_add_f32 v71, v44, v45
    v_max_f32 v46, v46, v71
    s_cbranch_vccnz L_f103
    s_waitcnt vmcnt(4)
L_f103:
    s_waitcnt vmcnt(6)
    buffer_load_dwordx4 v[180:183], v252, s[48:51], 0 offen offset:128 nt
    v_xor_b32 v252, 4866048, v2
    s_waitcnt lgkmcnt(0)
    v_cmp_lt_i32 vcc, 0, v250
    v_mov_b32 v249, 103
    ds_write_b32 v248, v249 offset:3296
    ds_read_b32 v250, v248 offset:3312
    s_cbranch_vccnz L_f104
    s_waitcnt vmcnt(4)
L_f104:
    s_waitcnt vmcnt(6)
    buffer_load_dwordx4 v[184:187], v252, s[48:51], 0 offen offset:0 nt
    s_cbranch_vccnz L_f105
    s_waitcnt vmcnt(4)
L_f105:
    s_waitcnt vmcnt(6)
    buffer_load_dwordx4 v[188:191], v252, s[48:51], 0 offen offset:128 nt
    v_xor_b32 v252, 4931584, v2
    s_waitcnt lgkmcnt(0)
    v_cmp_lt_i32 vcc, 0, v250
    v_mov_b32 v249, 105
    ds_write_b32 v248, v249 offset:3296
    ds_read_b32 v250, v248 offset:3312
    s_cbranch_vccnz L_f106
    s_waitcnt vmcnt(4)
L_f106:
    s_waitcnt vmcnt(6)
    buffer_load_dwordx4 v[192:195], v252, s[48:51], 0 offen offset:0 nt
    v_mfma_f32_16x16x32_bf16 v[32:35], v[152:155], v[8:11], 0
    v_mfma_f32_16x16x32_bf16 v[32:35], v[156:159], v[12:15], v[32:35]
    v_mfma_f32_16x16x32_bf16 v[32:35], v[160:163], v[16:19], v[32:35]
    v_mfma_f32_16x16x32_bf16 v[32:35], v[164:167], v[20:23], v[32:35]
    s_nop 7
    v_mov_b32_dpp v44, v32 quad_perm:[0,0,0,0] row_mask:0xf bank_mask:0xf
    v_mov_b32_dpp v45, v34 quad_perm:[2,2,2,2] row_mask:0xf bank_mask:0xf
    s_nop 0
    v_add_f32_dpp v44, v33, v44 quad_perm:[1,1,1,1] row_mask:0xf bank_mask:0xf
    v_add_f32_dpp v45, v35, v45 quad_perm:[3,3,3,3] row_mask:0xf bank_mask:0xf
    v_add_f32 v72, v44, v45
    v_max_f32 v46, v46, v72
    s_cbranch_vccnz L_f107
    s_waitcnt vmcnt(4)
L_f107:
    s_waitcnt vmcnt(6)
    buffer_load_dwordx4 v[196:199], v252, s[48:51], 0 offen offset:128 nt
    v_xor_b32 v252, 6963200, v2
    s_waitcnt lgkmcnt(0)
    v_cmp_lt_i32 vcc, 0, v250
    v_mov_b32 v249, 107
    ds_write_b32 v248, v249 offset:3296
    ds_read_b32 v250, v248 offset:3312
    s_cbranch_vccnz L_f108
    s_waitcnt vmcnt(4)
L_f108:
    s_waitcnt vmcnt(6)
    buffer_load_dwordx4 v[200:203], v252, s[48:51], 0 offen offset:0 nt
    s_cbranch_vccnz L_f109
    s_waitcnt vmcnt(4)
L_f109:
    s_waitcnt vmcnt(6)
    buffer_load_dwordx4 v[204:207], v252, s[48:51], 0 offen offset:128 nt
    v_xor_b32 v252, 7028736, v2
    s_waitcnt lgkmcnt(0)
    v_cmp_lt_i32 vcc, 0, v250
    v_mov_b32 v249, 109
    ds_write_b32 v248, v249 offset:3296
    ds_read_b32 v250, v248 offset:3312
    s_cbranch_vccnz L_f110
    s_waitcnt vmcnt(4)
L_f110:
    s_waitcnt vmcnt(6)
    buffer_load_dwordx4 v[208:211], v252, s[48:51], 0 offen offset:0 nt
    v_mfma_f32_16x16x32_bf16 v[32:35], v[168:171], v[8:11], 0
    v_mfma_f32_16x16x32_bf16 v[32:35], v[172:175], v[12:15], v[32:35]
    v_mfma_f32_16x16x32_bf16 v[32:35], v[176:179], v[16:19], v[32:35]
    v_mfma_f32_16x16x32_bf16 v[32:35], v[180:183], v[20:23], v[32:35]
    s_nop 7
    v_mov_b32_dpp v44, v32 quad_perm:[0,0,0,0] row_mask:0xf bank_mask:0xf
    v_mov_b32_dpp v45, v34 quad_perm:[2,2,2,2] row_mask:0xf bank_mask:0xf
    s_nop 0
    v_add_f32_dpp v44, v33, v44 quad_perm:[1,1,1,1] row_mask:0xf bank_mask:0xf
    v_add_f32_dpp v45, v35, v45 quad_perm:[3,3,3,3] row_mask:0xf bank_mask:0xf
    v_add_f32 v73, v44, v45
    v_max_f32 v46, v46, v73
    s_cbranch_vccnz L_f111
    s_waitcnt vmcnt(4)
L_f111:
    s_waitcnt vmcnt(6)
    buffer_load_dwordx4 v[212:215], v252, s[48:51], 0 offen offset:128 nt
    v_xor_b32 v252, 5788672, v2
    s_waitcnt lgkmcnt(0)
    v_cmp_lt_i32 vcc, 0, v250
    v_mov_b32 v249, 111
    ds_write_b32 v248, v249 offset:3296
    ds_read_b32 v250, v248 offset:3312
    s_cbranch_vccnz L_f112
    s_waitcnt vmcnt(4)
L_f112:
    s_waitcnt vmcnt(6)
    buffer_load_dwordx4 v[216:219], v252, s[48:51], 0 offen offset:0 nt
    s_cbranch_vccnz L_f113
    s_waitcnt vmcnt(4)
L_f113:
    s_waitcnt vmcnt(6)
    buffer_load_dwordx4 v[220:223], v252, s[48:51], 0 offen offset:128 nt
    v_xor_b32 v252, 5854208, v2
    s_waitcnt lgkmcnt(0)
    v_cmp_lt_i32 vcc, 0, v250
    v_mov_b32 v249, 113
    ds_write_b32 v248, v249 offset:3296
    ds_read_b32 v250, v248 offset:3312
    s_cbranch_vccnz L_f114
    s_waitcnt vmcnt(4)
L_f114:
    s_waitcnt vmcnt(6)
    buffer_load_dwordx4 v[224:227], v252, s[48:51], 0 offen offset:0 nt
    v_mfma_f32_16x16x32_bf16 v[32:35], v[184:187], v[8:11], 0
    v_mfma_f32_16x16x32_bf16 v[32:35], v[188:191], v[12:15], v[32:35]
    v_mfma_f32_16x16x32_bf16 v[32:35], v[192:195], v[16:19], v[32:35]
    v_mfma_f32_16x16x32_bf16 v[32:35], v[196:199], v[20:23], v[32:35]
    s_nop 7
    v_mov_b32_dpp v44, v32 quad_perm:[0,0,0,0] row_mask:0xf bank_mask:0xf
    v_mov_b32_dpp v45, v34 quad_perm:[2,2,2,2] row_mask:0xf bank_mask:0xf
    s_nop 0
    v_add_f32_dpp v44, v33, v44 quad_perm:[1,1,1,1] row_mask:0xf bank_mask:0xf
    v_add_f32_dpp v45, v35, v45 quad_perm:[3,3,3,3] row_mask:0xf bank_mask:0xf
    v_add_f32 v74, v44, v45
    v_max_f32 v46, v46, v74
    s_cbranch_vccnz L_f115
    s_waitcnt vmcnt(4)
L_f115:
    s_waitcnt vmcnt(6)
    buffer_load_dwordx4 v[228:231], v252, s[48:51], 0 offen offset:128 nt
    v_xor_b32 v252, 7885824, v2
    s_waitcnt lgkmcnt(0)
    v_cmp_lt_i32 vcc, 0, v250
    v_mov_b32 v249, 115
    ds_write_b32 v248, v249 offset:3296
    ds_read_b32 v250, v248 offset:3312
    s_cbranch_vccnz L_f116
    s_waitcnt vmcnt(4)
L_f116:
    s_waitcnt vmcnt(6)
    buffer_load_dwordx4 v[232:235], v252, s[48:51], 0 offen offset:0 nt
    s_cbranch_vccnz L_f117
    s_waitcnt vmcnt(4)
L_f117:
    s_waitcnt vmcnt(6)
    buffer_load_dwordx4 v[236:239], v252, s[48:51], 0 offen offset:128 nt
    v_xor_b32 v252, 7951360, v2
    s_waitcnt lgkmcnt(0)
    v_cmp_lt_i32 vcc, 0, v250
    v_mov_b32 v249, 117
    ds_write_b32 v248, v249 offset:3296
    ds_read_b32 v250, v248 offset:3312
    s_cbranch_vccnz L_f118
    s_waitcnt vmcnt(4)
L_f118:
    s_waitcnt vmcnt(6)
    buffer_load_dwordx4 v[240:243], v252, s[48:51], 0 offen offset:0 nt
    v_mfma_f32_16x16x32_bf16 v[32:35], v[200:203], v[8:11], 0
    v_mfma_f32_16x16x32_bf16 v[32:35], v[204:207], v[12:15], v[32:35]
    v_mfma_f32_16x16x32_bf16 v[32:35], v[208:211], v[16:19], v[32:35]
    v_mfma_f32_16x16x32_bf16 v[32:35], v[212:215], v[20:23], v[32:35]
    s_nop 7
    v_mov_b32_dpp v44, v32 quad_perm:[0,0,0,0] row_mask:0xf bank_mask:0xf
    v_mov_b32_dpp v45, v34 quad_perm:[2,2,2,2] row_mask:0xf bank_mask:0xf
    s_nop 0
    v_add_f32_dpp v44, v33, v44 quad_perm:[1,1,1,1] row_mask:0xf bank_mask:0xf
    v_add_f32_dpp v45, v35, v45 quad_perm:[3,3,3,3] row_mask:0xf bank_mask:0xf
    v_add_f32 v75, v44, v45
    v_max_f32 v46, v46, v75
    s_cbranch_vccnz L_f119
    s_waitcnt vmcnt(4)
L_f119:
    s_waitcnt vmcnt(6)
    buffer_load_dwordx4 v[244:247], v252, s[48:51], 0 offen offset:128 nt
    v_xor_b32 v252, 5918720, v2
    s_waitcnt lgkmcnt(0)
    v_cmp_lt_i32 vcc, 0, v250
    v_mov_b32 v249, 119
    ds_write_b32 v248, v249 offset:3296
    ds_read_b32 v250, v248 offset:3312
    s_cbranch_vccnz L_f120
    s_waitcnt vmcnt(4)
L_f120:
    s_waitcnt vmcnt(6)
    buffer_load_dwordx4 v[88:91], v252, s[48:51], 0 offen offset:0 nt
    s_cbranch_vccnz L_f121
    s_waitcnt vmcnt(4)
L_f121:
    s_waitcnt vmcnt(6)
    buffer_load_dwordx4 v[92:95], v252, s[48:51], 0 offen offset:128 nt
    v_xor_b32 v252, 5984256, v2
    s_waitcnt lgkmcnt(0)
    v_cmp_lt_i32 vcc, 0, v250
    v_mov_b32 v249, 121
    ds_write_b32 v248, v249 offset:3296
    ds_read_b32 v250, v248 offset:3312
    s_cbranch_vccnz L_f122
    s_waitcnt vmcnt(4)
L_f122:
    s_waitcnt vmcnt(6)
    buffer_load_dwordx4 v[96:99], v252, s[48:51], 0 offen offset:0 nt
    v_mfma_f32_16x16x32_bf16 v[32:35], v[216:219], v[8:11], 0
    v_mfma_f32_16x16x32_bf16 v[32:35], v[220:223], v[12:15], v[32:35]
    v_mfma_f32_16x16x32_bf16 v[32:35], v[224:227], v[16:19], v[32:35]
    v_mfma_f32_16x16x32_bf16 v[32:35], v[228:231], v[20:23], v[32:35]
    s_nop 7
    v_mov_b32_dpp v44, v32 quad_perm:[0,0,0,0] row_mask:0xf bank_mask:0xf
    v_mov_b32_dpp v45, v34 quad_perm:[2,2,2,2] row_mask:0xf bank_mask:0xf
    s_nop 0
    v_add_f32_dpp v44, v33, v44 quad_perm:[1,1,1,1] row_mask:0xf bank_mask:0xf
    v_add_f32_dpp v45, v35, v45 quad_perm:[3,3,3,3] row_mask:0xf bank_mask:0xf
    v_add_f32 v76, v44, v45
    v_max_f32 v46, v46, v76
    s_cbranch_vccnz L_f123
    s_waitcnt vmcnt(4)
L_f123:
    s_waitcnt vmcnt(6)
    buffer_load_dwordx4 v[100:103], v252, s[48:51], 0 offen offset:128 nt
    v_xor_b32 v252, 8015872, v2
    s_waitcnt lgkmcnt(0)
    v_cmp_lt_i32 vcc, 0, v250
    v_mov_b32 v249, 123
    ds_write_b32 v248, v249 offset:3296
    ds_read_b32 v250, v248 offset:3312
    s_cbranch_vccnz L_f124
    s_waitcnt vmcnt(4)
L_f124:
    s_waitcnt vmcnt(6)
    buffer_load_dwordx4 v[104:107], v252, s[48:51], 0 offen offset:0 nt
    s_cbranch_vccnz L_f125
    s_waitcnt vmcnt(4)
L_f125:
    s_waitcnt vmcnt(6)
    buffer_load_dwordx4 v[108:111], v252, s[48:51], 0 offen offset:128 nt
    v_xor_b32 v252, 8081408, v2
    s_waitcnt lgkmcnt(0)
    v_cmp_lt_i32 vcc, 0, v250
    v_mov_b32 v249, 125
    ds_write_b32 v248, v249 offset:3296
    ds_read_b32 v250, v248 offset:3312
    s_cbranch_vccnz L_f126
    s_waitcnt vmcnt(4)
L_f126:
    s_waitcnt vmcnt(6)
    buffer_load_dwordx4 v[112:115], v252, s[48:51], 0 offen offset:0 nt
    v_mfma_f32_16x16x32_bf16 v[32:35], v[232:235], v[8:11], 0
    v_mfma_f32_16x16x32_bf16 v[32:35], v[236:239], v[12:15], v[32:35]
    v_mfma_f32_16x16x32_bf16 v[32:35], v[240:243], v[16:19], v[32:35]
    v_mfma_f32_16x16x32_bf16 v[32:35], v[244:247], v[20:23], v[32:35]
    s_nop 7
    v_mov_b32_dpp v44, v32 quad_perm:[0,0,0,0] row_mask:0xf bank_mask:0xf
    v_mov_b32_dpp v45, v34 quad_perm:[2,2,2,2] row_mask:0xf bank_mask:0xf
    s_nop 0
    v_add_f32_dpp v44, v33, v44 quad_perm:[1,1,1,1] row_mask:0xf bank_mask:0xf
    v_add_f32_dpp v45, v35, v45 quad_perm:[3,3,3,3] row_mask:0xf bank_mask:0xf
    v_add_f32 v77, v44, v45
    v_max_f32 v46, v46, v77
    s_cbranch_vccnz L_f127
    s_waitcnt vmcnt(4)
L_f127:
    s_waitcnt vmcnt(6)
    buffer_load_dwordx4 v[116:119], v252, s[48:51], 0 offen offset:128 nt
    v_xor_b32 v252, 0, v3
    s_waitcnt lgkmcnt(0)
    v_cmp_lt_i32 vcc, 0, v250
    v_mov_b32 v249, 127
    ds_write_b32 v248, v249 offset:3296
    ds_read_b32 v250, v248 offset:3312
    s_cbranch_vccnz L_f128
    s_waitcnt vmcnt(4)
L_f128:
    s_waitcnt vmcnt(6)
    buffer_load_dwordx4 v[120:123], v252, s[64:67], 0 offen offset:0 nt
    s_cbranch_vccnz L_f129
    s_waitcnt vmcnt(4)
L_f129:
    s_waitcnt vmcnt(6)
    buffer_load_dwordx4 v[124:127], v252, s[64:67], 0 offen offset:128 nt
    v_xor_b32 v252, 65536, v3
    s_waitcnt lgkmcnt(0)
    v_cmp_lt_i32 vcc, 0, v250
    v_mov_b32 v249, 129
    ds_write_b32 v248, v249 offset:3296
    ds_read_b32 v250, v248 offset:3312
    s_cbranch_vccnz L_f130
    s_waitcnt vmcnt(4)
L_f130:
    s_waitcnt vmcnt(6)
    buffer_load_dwordx4 v[128:131], v252, s[64:67], 0 offen offset:0 nt
    v_mfma_f32_16x16x32_bf16 v[32:35], v[88:91], v[8:11], 0
    v_mfma_f32_16x16x32_bf16 v[32:35], v[92:95], v[12:15], v[32:35]
    v_mfma_f32_16x16x32_bf16 v[32:35], v[96:99], v[16:19], v[32:35]
    v_mfma_f32_16x16x32_bf16 v[32:35], v[100:103], v[20:23], v[32:35]
    s_nop 7
    v_mov_b32_dpp v44, v32 quad_perm:[0,0,0,0] row_mask:0xf bank_mask:0xf
    v_mov_b32_dpp v45, v34 quad_perm:[2,2,2,2] row_mask:0xf bank_mask:0xf
    s_nop 0
    v_add_f32_dpp v44, v33, v44 quad_perm:[1,1,1,1] row_mask:0xf bank_mask:0xf
    v_add_f32_dpp v45, v35, v45 quad_perm:[3,3,3,3] row_mask:0xf bank_mask:0xf
    v_add_f32 v78, v44, v45
    v_max_f32 v46, v46, v78
    s_cbranch_vccnz L_f131
    s_waitcnt vmcnt(4)
L_f131:
    s_waitcnt vmcnt(6)
    buffer_load_dwordx4 v[132:135], v252, s[64:67], 0 offen offset:128 nt
    v_xor_b32 v252, 2097152, v3
    s_waitcnt lgkmcnt(0)
    v_cmp_lt_i32 vcc, 0, v250
    v_mov_b32 v249, 131
    ds_write_b32 v248, v249 offset:3296
    ds_read_b32 v250, v248 offset:3312
    s_cbranch_vccnz L_f132
    s_waitcnt vmcnt(4)
L_f132:
    s_waitcnt vmcnt(6)
    buffer_load_dwordx4 v[136:139], v252, s[64:67], 0 offen offset:0 nt
    s_cbranch_vccnz L_f133
    s_waitcnt vmcnt(4)
L_f133:
    s_waitcnt vmcnt(6)
    buffer_load_dwordx4 v[140:143], v252, s[64:67], 0 offen offset:128 nt
    v_xor_b32 v252, 2162688, v3
    s_waitcnt lgkmcnt(0)
    v_cmp_lt_i32 vcc, 0, v250
    v_mov_b32 v249, 133
    ds_write_b32 v248, v249 offset:3296
    ds_read_b32 v250, v248 offset:3312
    s_cbranch_vccnz L_f134
    s_waitcnt vmcnt(4)
L_f134:
    s_waitcnt vmcnt(6)
    buffer_load_dwordx4 v[144:147], v252, s[64:67], 0 offen offset:0 nt
    v_mfma_f32_16x16x32_bf16 v[32:35], v[104:107], v[8:11], 0
    v_mfma_f32_16x16x32_bf16 v[32:35], v[108:111], v[12:15], v[32:35]
    v_mfma_f32_16x16x32_bf16 v[32:35], v[112:115], v[16:19], v[32:35]
    v_mfma_f32_16x16x32_bf16 v[32:35], v[116:119], v[20:23], v[32:35]
    s_nop 7
    v_mov_b32_dpp v44, v32 quad_perm:[0,0,0,0] row_mask:0xf bank_mask:0xf
    v_mov_b32_dpp v45, v34 quad_perm:[2,2,2,2] row_mask:0xf bank_mask:0xf
    s_nop 0
    v_add_f32_dpp v44, v33, v44 quad_perm:[1,1,1,1] row_mask:0xf bank_mask:0xf
    v_add_f32_dpp v45, v35, v45 quad_perm:[3,3,3,3] row_mask:0xf bank_mask:0xf
    v_add_f32 v79, v44, v45
    v_max_f32 v46, v46, v79
    s_cbranch_vccnz L_f135
    s_waitcnt vmcnt(4)
L_f135:
    s_waitcnt vmcnt(6)
    buffer_load_dwordx4 v[148:151], v252, s[64:67], 0 offen offset:128 nt
    v_xor_b32 v252, 132096, v3
    s_waitcnt lgkmcnt(0)
    v_cmp_lt_i32 vcc, 0, v250
    v_mov_b32 v249, 135
    ds_write_b32 v248, v249 offset:3296
    ds_read_b32 v250, v248 offset:3312
    s_nop 1
    v_max_f32_dpp v46, v46, v46 row_half_mirror row_mask:0xf bank_mask:0xf
    v_mov_b32 v44, v46
    s_nop 1
    v_permlane16_swap_b32 v44, v46
    s_nop 1
    v_max_f32 v46, v44, v46
    v_mov_b32 v44, v46
    s_nop 1
    v_permlane32_swap_b32 v44, v46
    s_nop 1
    v_max_f32 v46, v44, v46
    s_cbranch_vccnz L_f136
    s_waitcnt vmcnt(4)
L_f136:
    s_waitcnt vmcnt(6)
    buffer_load_dwordx4 v[152:155], v252, s[64:67], 0 offen offset:0 nt
    v_sub_f32 v48, v48, v46
    v_sub_f32 v49, v49, v46
    v_sub_f32 v50, v50, v46
    v_sub_f32 v51, v51, v46
    v_sub_f32 v52, v52, v46
    v_sub_f32 v53, v53, v46
    v_sub_f32 v54, v54, v46
    v_sub_f32 v55, v55, v46
    v_mul_f32 v48, s43, v48
    v_mul_f32 v49, s43, v49
    v_mul_f32 v50, s43, v50
    v_mul_f32 v51, s43, v51
    v_mul_f32 v52, s43, v52
    v_mul_f32 v53, s43, v53
    v_mul_f32 v54, s43, v54
    v_mul_f32 v55, s43, v55
    v_exp_f32 v48, v48
    v_exp_f32 v49, v49
    v_exp_f32 v50, v50
    v_exp_f32 v51, v51
    v_exp_f32 v52, v52
    v_exp_f32 v53, v53
    v_exp_f32 v54, v54
    v_exp_f32 v55, v55
    s_nop 0
    v_add_f32 v47, v47, v48
    v_cvt_pk_bf16_f32 v48, v48, v48
    v_add_f32 v47, v47, v49
    v_cvt_pk_bf16_f32 v49, v49, v49
    v_add_f32 v47, v47, v50
    v_cvt_pk_bf16_f32 v50, v50, v50
    v_add_f32 v47, v47, v51
    v_cvt_pk_bf16_f32 v51, v51, v51
    v_add_f32 v47, v47, v52
    v_cvt_pk_bf16_f32 v52, v52, v52
    v_add_f32 v47, v47, v53
    v_cvt_pk_bf16_f32 v53, v53, v53
    v_add_f32 v47, v47, v54
    v_cvt_pk_bf16_f32 v54, v54, v54
    v_add_f32 v47, v47, v55
    v_cvt_pk_bf16_f32 v55, v55, v55
    s_cbranch_vccnz L_f137
    s_waitcnt vmcnt(4)
L_f137:
    s_waitcnt vmcnt(6)
    buffer_load_dwordx4 v[156:159], v252, s[64:67], 0 offen offset:128 nt
    v_xor_b32 v252, 197632, v3
    s_waitcnt lgkmcnt(0)
    v_cmp_lt_i32 vcc, 0, v250
    v_mov_b32 v249, 137
    ds_write_b32 v248, v249 offset:3296
    ds_read_b32 v250, v248 offset:3312
    v_sub_f32 v56, v56, v46
    v_sub_f32 v57, v57, v46
    v_sub_f32 v58, v58, v46
    v_sub_f32 v59, v59, v46
    v_sub_f32 v60, v60, v46
    v_sub_f32 v61, v61, v46
    v_sub_f32 v62, v62, v46
    v_sub_f32 v63, v63, v46
    v_mul_f32 v56, s43, v56
    v_mul_f32 v57, s43, v57
    v_mul_f32 v58, s43, v58
    v_mul_f32 v59, s43, v59
    v_mul_f32 v60, s43, v60
    v_mul_f32 v61, s43, v61
    v_mul_f32 v62, s43, v62
    v_mul_f32 v63, s43, v63
    v_exp_f32 v56, v56
    v_exp_f32 v57, v57
    v_exp_f32 v58, v58
    v_exp_f32 v59, v59
    v_exp_f32 v60, v60
    v_exp_f32 v61, v61
    v_exp_f32 v62, v62
    v_exp_f32 v63, v63
    s_nop 0
    v_add_f32 v47, v47, v56
    v_cvt_pk_bf16_f32 v56, v56, v56
    v_add_f32 v47, v47, v57
    v_cvt_pk_bf16_f32 v57, v57, v57
    v_add_f32 v47, v47, v58
    v_cvt_pk_bf16_f32 v58, v58, v58
    v_add_f32 v47, v47, v59
    v_cvt_pk_bf16_f32 v59, v59, v59
    v_add_f32 v47, v47, v60
    v_cvt_pk_bf16_f32 v60, v60, v60
    v_add_f32 v47, v47, v61
    v_cvt_pk_bf16_f32 v61, v61, v61
    v_add_f32 v47, v47, v62
    v_cvt_pk_bf16_f32 v62, v62, v62
    v_add_f32 v47, v47, v63
    v_cvt_pk_bf16_f32 v63, v63, v63
    s_cbranch_vccnz L_f138
    s_waitcnt vmcnt(4)
L_f138:
    s_waitcnt vmcnt(6)
    buffer_load_dwordx4 v[160:163], v252, s[64:67], 0 offen offset:0 nt
    v_sub_f32 v64, v64, v46
    v_sub_f32 v65, v65, v46
    v_sub_f32 v66, v66, v46
    v_sub_f32 v67, v67, v46
    v_sub_f32 v68, v68, v46
    v_sub_f32 v69, v69, v46
    v_sub_f32 v70, v70, v46
    v_sub_f32 v71, v71, v46
    v_mul_f32 v64, s43, v64
    v_mul_f32 v65, s43, v65
    v_mul_f32 v66, s43, v66
    v_mul_f32 v67, s43, v67
    v_mul_f32 v68, s43, v68
    v_mul_f32 v69, s43, v69
    v_mul_f32 v70, s43, v70
    v_mul_f32 v71, s43, v71
    v_exp_f32 v64, v64
    v_exp_f32 v65, v65
    v_exp_f32 v66, v66
    v_exp_f32 v67, v67
    v_exp_f32 v68, v68
    v_exp_f32 v69, v69
    v_exp_f32 v70, v70
    v_exp_f32 v71, v71
    s_nop 0
    v_add_f32 v47, v47, v64
    v_cvt_pk_bf16_f32 v64, v64, v64
    v_add_f32 v47, v47, v65
    v_cvt_pk_bf16_f32 v65, v65, v65
    v_add_f32 v47, v47, v66
    v_cvt_pk_bf16_f32 v66, v66, v66
    v_add_f32 v47, v47, v67
    v_cvt_pk_bf16_f32 v67, v67, v67
    v_add_f32 v47, v47, v68
    v_cvt_pk_bf16_f32 v68, v68, v68
    v_add_f32 v47, v47, v69
    v_cvt_pk_bf16_f32 v69, v69, v69
    v_add_f32 v47, v47, v70
    v_cvt_pk_bf16_f32 v70, v70, v70
    v_add_f32 v47, v47, v71
    v_cvt_pk_bf16_f32 v71, v71, v71
    s_cbranch_vccnz L_f139
    s_waitcnt vmcnt(4)
L_f139:
    s_waitcnt vmcnt(6)
    buffer_load_dwordx4 v[164:167], v252, s[64:67], 0 offen offset:128 nt
    v_xor_b32 v252, 2229248, v3
    s_waitcnt lgkmcnt(0)
    v_cmp_lt_i32 vcc, 0, v250
    v_mov_b32 v249, 139
    ds_write_b32 v248, v249 offset:3296
    ds_read_b32 v250, v248 offset:3312
    v_sub_f32 v72, v72, v46
    v_sub_f32 v73, v73, v46
    v_sub_f32 v74, v74, v46
    v_sub_f32 v75, v75, v46
    v_sub_f32 v76, v76, v46
    v_sub_f32 v77, v77, v46
    v_sub_f32 v78, v78, v46
    v_sub_f32 v79, v79, v46
    v_mul_f32 v72, s43, v72
    v_mul_f32 v73, s43, v73
    v_mul_f32 v74, s43, v74
    v_mul_f32 v75, s43, v75
    v_mul_f32 v76, s43, v76
    v_mul_f32 v77, s43, v77
    v_mul_f32 v78, s43, v78
    v_mul_f32 v79, s43, v79
    v_exp_f32 v72, v72
    v_exp_f32 v73, v73
    v_exp_f32 v74, v74
    v_exp_f32 v75, v75
    v_exp_f32 v76, v76
    v_exp_f32 v77, v77
    v_exp_f32 v78, v78
    v_exp_f32 v79, v79
    s_nop 0
    v_add_f32 v47, v47, v72
    v_cvt_pk_bf16_f32 v72, v72, v72
    v_add_f32 v47, v47, v73
    v_cvt_pk_bf16_f32 v73, v73, v73
    v_add_f32 v47, v47, v74
    v_cvt_pk_bf16_f32 v74, v74, v74
    v_add_f32 v47, v47, v75
    v_cvt_pk_bf16_f32 v75, v75, v75
    v_add_f32 v47, v47, v76
    v_cvt_pk_bf16_f32 v76, v76, v76
    v_add_f32 v47, v47, v77
    v_cvt_pk_bf16_f32 v77, v77, v77
    v_add_f32 v47, v47, v78
    v_cvt_pk_bf16_f32 v78, v78, v78
    v_add_f32 v47, v47, v79
    v_cvt_pk_bf16_f32 v79, v79, v79
    s_cbranch_vccnz L_f140
    s_waitcnt vmcnt(4)
L_f140:
    s_waitcnt vmcnt(6)
    buffer_load_dwordx4 v[168:171], v252, s[64:67], 0 offen offset:0 nt
    s_nop 1
    v_add_f32_dpp v47, v47, v47 row_half_mirror row_mask:0xf bank_mask:0xf
    v_mov_b32 v44, v47
    s_nop 1
    v_permlane16_swap_b32 v44, v47
    s_nop 1
    v_add_f32 v47, v44, v47
    v_mov_b32 v44, v47
    s_nop 1
    v_permlane32_swap_b32 v44, v47
    s_nop 1
    v_add_f32 v47, v44, v47
    v_bfe_u32 v44, v1, 3, 1
    v_lshlrev_b32 v44, 5, v44
    s_lshl_b32 s11, s3, 3
    v_add_u32 v44, s11, v44
    ds_write_b64 v44, v[46:47] offset:3072
    s_cbranch_vccnz L_f141
    s_waitcnt vmcnt(4)
L_f141:
    s_waitcnt vmcnt(6)
    buffer_load_dwordx4 v[172:175], v252, s[64:67], 0 offen offset:128 nt
    v_xor_b32 v252, 2294784, v3
    s_waitcnt lgkmcnt(0)
    v_cmp_lt_i32 vcc, 0, v250
    v_mov_b32 v249, 141
    ds_write_b32 v248, v249 offset:3296
    ds_read_b32 v250, v248 offset:3312
    v_and_b32 v36, v48, v4
    v_and_b32 v37, v48, v5
    v_and_b32_dpp v38, v48, v6 row_half_mirror row_mask:0xf bank_mask:0xf
    v_and_b32_dpp v39, v48, v7 row_half_mirror row_mask:0xf bank_mask:0xf
    v_and_b32_dpp v40, v48, v4 row_half_mirror row_mask:0xf bank_mask:0xf
    v_and_b32_dpp v41, v48, v5 row_half_mirror row_mask:0xf bank_mask:0xf
    v_and_b32 v42, v48, v6
    v_and_b32 v43, v48, v7
    s_nop 1
    v_mfma_f32_16x16x32_bf16 v[24:27], v[36:39], v[120:123], v[24:27]
    v_mfma_f32_16x16x32_bf16 v[28:31], v[36:39], v[124:127], v[28:31]
    v_mfma_f32_16x16x32_bf16 v[24:27], v[40:43], v[128:131], v[24:27]
    v_mfma_f32_16x16x32_bf16 v[28:31], v[40:43], v[132:135], v[28:31]
    s_cbranch_vccnz L_f142
    s_waitcnt vmcnt(4)
L_f142:
    s_waitcnt vmcnt(6)
    buffer_load_dwordx4 v[176:179], v252, s[64:67], 0 offen offset:0 nt
    v_and_b32 v36, v49, v4
    v_and_b32 v37, v49, v5
    v_and_b32_dpp v38, v49, v6 row_half_mirror row_mask:0xf bank_mask:0xf
    v_and_b32_dpp v39, v49, v7 row_half_mirror row_mask:0xf bank_mask:0xf
    v_and_b32_dpp v40, v49, v4 row_half_mirror row_mask:0xf bank_mask:0xf
    v_and_b32_dpp v41, v49, v5 row_half_mirror row_mask:0xf bank_mask:0xf
    v_and_b32 v42, v49, v6
    v_and_b32 v43, v49, v7
    s_nop 1
    v_mfma_f32_16x16x32_bf16 v[24:27], v[36:39], v[136:139], v[24:27]
    v_mfma_f32_16x16x32_bf16 v[28:31], v[36:39], v[140:143], v[28:31]
    v_mfma_f32_16x16x32_bf16 v[24:27], v[40:43], v[144:147], v[24:27]
    v_mfma_f32_16x16x32_bf16 v[28:31], v[40:43], v[148:151], v[28:31]
    s_cbranch_vccnz L_f143
    s_waitcnt vmcnt(4)
L_f143:
    s_waitcnt vmcnt(6)
    buffer_load_dwordx4 v[180:183], v252, s[64:67], 0 offen offset:128 nt
    v_xor_b32 v252, 1052672, v3
    s_waitcnt lgkmcnt(0)
    v_cmp_lt_i32 vcc, 0, v250
    v_mov_b32 v249, 143
    ds_write_b32 v248, v249 offset:3296
    ds_read_b32 v250, v248 offset:3312
    s_cbranch_vccnz L_f144
    s_waitcnt vmcnt(4)
L_f144:
    s_waitcnt vmcnt(6)
    buffer_load_dwordx4 v[184:187], v252, s[64:67], 0 offen offset:0 nt
    s_cbranch_vccnz L_f145
    s_waitcnt vmcnt(4)
L_f145:
    s_waitcnt vmcnt(6)
    buffer_load_dwordx4 v[188:191], v252, s[64:67], 0 offen offset:128 nt
    v_xor_b32 v252, 1118208, v3
    s_waitcnt lgkmcnt(0)
    v_cmp_lt_i32 vcc, 0, v250
    v_mov_b32 v249, 145
    ds_write_b32 v248, v249 offset:3296
    ds_read_b32 v250, v248 offset:3312
    s_cbranch_vccnz L_f146
    s_waitcnt vmcnt(4)
L_f146:
    s_waitcnt vmcnt(6)
    buffer_load_dwordx4 v[192:195], v252, s[64:67], 0 offen offset:0 nt
    v_and_b32 v36, v50, v4
    v_and_b32 v37, v50, v5
    v_and_b32_dpp v38, v50, v6 row_half_mirror row_mask:0xf bank_mask:0xf
    v_and_b32_dpp v39, v50, v7 row_half_mirror row_mask:0xf bank_mask:0xf
    v_and_b32_dpp v40, v50, v4 row_half_mirror row_mask:0xf bank_mask:0xf
    v_and_b32_dpp v41, v50, v5 row_half_mirror row_mask:0xf bank_mask:0xf
    v_and_b32 v42, v50, v6
    v_and_b32 v43, v50, v7
    s_nop 1
    v_mfma_f32_16x16x32_bf16 v[24:27], v[36:39], v[152:155], v[24:27]
    v_mfma_f32_16x16x32_bf16 v[28:31], v[36:39], v[156:159], v[28:31]
    v_mfma_f32_16x16x32_bf16 v[24:27], v[40:43], v[160:163], v[24:27]
    v_mfma_f32_16x16x32_bf16 v[28:31], v[40:43], v[164:167], v[28:31]
    s_cbranch_vccnz L_f147
    s_waitcnt vmcnt(4)
L_f147:
    s_waitcnt vmcnt(6)
    buffer_load_dwordx4 v[196:199], v252, s[64:67], 0 offen offset:128 nt
    v_xor_b32 v252, 3149824, v3
    s_waitcnt lgkmcnt(0)
    v_cmp_lt_i32 vcc, 0, v250
    v_mov_b32 v249, 147
    ds_write_b32 v248, v249 offset:3296
    ds_read_b32 v250, v248 offset:3312
    s_cbranch_vccnz L_f148
    s_waitcnt vmcnt(4)
L_f148:
    s_waitcnt vmcnt(6)
    buffer_load_dwordx4 v[200:203], v252, s[64:67], 0 offen offset:0 nt
    s_cbranch_vccnz L_f149
    s_waitcnt vmcnt(4)
L_f149:
    s_waitcnt vmcnt(6)
    buffer_load_dwordx4 v[204:207], v252, s[64:67], 0 offen offset:128 nt
    v_xor_b32 v252, 3215360, v3
    s_waitcnt lgkmcnt(0)
    v_cmp_lt_i32 vcc, 0, v250
    v_mov_b32 v249, 149
    ds_write_b32 v248, v249 offset:3296
    ds_read_b32 v250, v248 offset:3312
    s_cbranch_vccnz L_f150
    s_waitcnt vmcnt(4)
L_f150:
    s_waitcnt vmcnt(6)
    buffer_load_dwordx4 v[208:211], v252, s[64:67], 0 offen offset:0 nt
    v_and_b32 v36, v51, v4
    v_and_b32 v37, v51, v5
    v_and_b32_dpp v38, v51, v6 row_half_mirror row_mask:0xf bank_mask:0xf
    v_and_b32_dpp v39, v51, v7 row_half_mirror row_mask:0xf bank_mask:0xf
    v_and_b32_dpp v40, v51, v4 row_half_mirror row_mask:0xf bank_mask:0xf
    v_and_b32_dpp v41, v51, v5 row_half_mirror row_mask:0xf bank_mask:0xf
    v_and_b32 v42, v51, v6
    v_and_b32 v43, v51, v7
    s_nop 1
    v_mfma_f32_16x16x32_bf16 v[24:27], v[36:39], v[168:171], v[24:27]
    v_mfma_f32_16x16x32_bf16 v[28:31], v[36:39], v[172:175], v[28:31]
    v_mfma_f32_16x16x32_bf16 v[24:27], v[40:43], v[176:179], v[24:27]
    v_mfma_f32_16x16x32_bf16 v[28:31], v[40:43], v[180:183], v[28:31]
    s_cbranch_vccnz L_f151
    s_waitcnt vmcnt(4)
L_f151:
    s_waitcnt vmcnt(6)
    buffer_load_dwordx4 v[212:215], v252, s[64:67], 0 offen offset:128 nt
    v_xor_b32 v252, 1184768, v3
    s_waitcnt lgkmcnt(0)
    v_cmp_lt_i32 vcc, 0, v250
    v_mov_b32 v249, 151
    ds_write_b32 v248, v249 offset:3296
    ds_read_b32 v250, v248 offset:3312
    s_cbranch_vccnz L_f152
    s_waitcnt vmcnt(4)
L_f152:
    s_waitcnt vmcnt(6)
    buffer_load_dwordx4 v[216:219], v252, s[64:67], 0 offen offset:0 nt
    s_cbranch_vccnz L_f153
    s_waitcnt vmcnt(4)
L_f153:
    s_waitcnt vmcnt(6)
    buffer_load_dwordx4 v[220:223], v252, s[64:67], 0 offen offset:128 nt
    v_xor_b32 v252, 1250304, v3
    s_waitcnt lgkmcnt(0)
    v_cmp_lt_i32 vcc, 0, v250
    v_mov_b32 v249, 153
    ds_write_b32 v248, v249 offset:3296
    ds_read_b32 v250, v248 offset:3312
    s_cbranch_vccnz L_f154
    s_waitcnt vmcnt(4)
L_f154:
    s_waitcnt vmcnt(6)
    buffer_load_dwordx4 v[224:227], v252, s[64:67], 0 offen offset:0 nt
    v_and_b32 v36, v52, v4
    v_and_b32 v37, v52, v5
    v_and_b32_dpp v38, v52, v6 row_half_mirror row_mask:0xf bank_mask:0xf
    v_and_b32_dpp v39, v52, v7 row_half_mirror row_mask:0xf bank_mask:0xf
    v_and_b32_dpp v40, v52, v4 row_half_mirror row_mask:0xf bank_mask:0xf
    v_and_b32_dpp v41, v52, v5 row_half_mirror row_mask:0xf bank_mask:0xf
    v_and_b32 v42, v52, v6
    v_and_b32 v43, v52, v7
    s_nop 1
    v_mfma_f32_16x16x32_bf16 v[24:27], v[36:39], v[184:187], v[24:27]
    v_mfma_f32_16x16x32_bf16 v[28:31], v[36:39], v[188:191], v[28:31]
    v_mfma_f32_16x16x32_bf16 v[24:27], v[40:43], v[192:195], v[24:27]
    v_mfma_f32_16x16x32_bf16 v[28:31], v[40:43], v[196:199], v[28:31]
    s_cbranch_vccnz L_f155
    s_waitcnt vmcnt(4)
L_f155:
    s_waitcnt vmcnt(6)
    buffer_load_dwordx4 v[228:231], v252, s[64:67], 0 offen offset:128 nt
    v_xor_b32 v252, 3281920, v3
    s_waitcnt lgkmcnt(0)
    v_cmp_lt_i32 vcc, 0, v250
    v_mov_b32 v249, 155
    ds_write_b32 v248, v249 offset:3296
    ds_read_b32 v250, v248 offset:3312
    s_cbranch_vccnz L_f156
    s_waitcnt vmcnt(4)
L_f156:
    s_waitcnt vmcnt(6)
    buffer_load_dwordx4 v[232:235], v252, s[64:67], 0 offen offset:0 nt
    s_cbranch_vccnz L_f157
    s_waitcnt vmcnt(4)
L_f157:
    s_waitcnt vmcnt(6)
    buffer_load_dwordx4 v[236:239], v252, s[64:67], 0 offen offset:128 nt
    v_xor_b32 v252, 3347456, v3
    s_waitcnt lgkmcnt(0)
    v_cmp_lt_i32 vcc, 0, v250
    v_mov_b32 v249, 157
    ds_write_b32 v248, v249 offset:3296
    ds_read_b32 v250, v248 offset:3312
    s_cbranch_vccnz L_f158
    s_waitcnt vmcnt(4)
L_f158:
    s_waitcnt vmcnt(6)
    buffer_load_dwordx4 v[240:243], v252, s[64:67], 0 offen offset:0 nt
    v_and_b32 v36, v53, v4
    v_and_b32 v37, v53, v5
    v_and_b32_dpp v38, v53, v6 row_half_mirror row_mask:0xf bank_mask:0xf
    v_and_b32_dpp v39, v53, v7 row_half_mirror row_mask:0xf bank_mask:0xf
    v_and_b32_dpp v40, v53, v4 row_half_mirror row_mask:0xf bank_mask:0xf
    v_and_b32_dpp v41, v53, v5 row_half_mirror row_mask:0xf bank_mask:0xf
    v_and_b32 v42, v53, v6
    v_and_b32 v43, v53, v7
    s_nop 1
    v_mfma_f32_16x16x32_bf16 v[24:27], v[36:39], v[200:203], v[24:27]
    v_mfma_f32_16x16x32_bf16 v[28:31], v[36:39], v[204:207], v[28:31]
    v_mfma_f32_16x16x32_bf16 v[24:27], v[40:43], v[208:211], v[24:27]
    v_mfma_f32_16x16x32_bf16 v[28:31], v[40:43], v[212:215], v[28:31]
    s_cbranch_vccnz L_f159
    s_waitcnt vmcnt(4)
L_f159:
    s_waitcnt vmcnt(6)
    buffer_load_dwordx4 v[244:247], v252, s[64:67], 0 offen offset:128 nt
    v_xor_b32 v252, 541696, v3
    s_waitcnt lgkmcnt(0)
    v_cmp_lt_i32 vcc, 0, v250
    v_mov_b32 v249, 159
    ds_write_b32 v248, v249 offset:3296
    ds_read_b32 v250, v248 offset:3312
    s_cbranch_vccnz L_f160
    s_waitcnt vmcnt(4)
L_f160:
    s_waitcnt vmcnt(6)
    buffer_load_dwordx4 v[88:91], v252, s[64:67], 0 offen offset:0 nt
    s_cbranch_vccnz L_f161
    s_waitcnt vmcnt(4)
L_f161:
    s_waitcnt vmcnt(6)
    buffer_load_dwordx4 v[92:95], v252, s[64:67], 0 offen offset:128 nt
    v_xor_b32 v252, 607232, v3
    s_waitcnt lgkmcnt(0)
    v_cmp_lt_i32 vcc, 0, v250
    v_mov_b32 v249, 161
    ds_write_b32 v248, v249 offset:3296
    ds_read_b32 v250, v248 offset:3312
    s_cbranch_vccnz L_f162
    s_waitcnt vmcnt(4)
L_f162:
    s_waitcnt vmcnt(6)
    buffer_load_dwordx4 v[96:99], v252, s[64:67], 0 offen offset:0 nt
    v_and_b32 v36, v54, v4
    v_and_b32 v37, v54, v5
    v_and_b32_dpp v38, v54, v6 row_half_mirror row_mask:0xf bank_mask:0xf
    v_and_b32_dpp v39, v54, v7 row_half_mirror row_mask:0xf bank_mask:0xf
    v_and_b32_dpp v40, v54, v4 row_half_mirror row_mask:0xf bank_mask:0xf
    v_and_b32_dpp v41, v54, v5 row_half_mirror row_mask:0xf bank_mask:0xf
    v_and_b32 v42, v54, v6
    v_and_b32 v43, v54, v7
    s_nop 1
    v_mfma_f32_16x16x32_bf16 v[24:27], v[36:39], v[216:219], v[24:27]
    v_mfma_f32_16x16x32_bf16 v[28:31], v[36:39], v[220:223], v[28:31]
    v_mfma_f32_16x16x32_bf16 v[24:27], v[40:43], v[224:227], v[24:27]
    v_mfma_f32_16x16x32_bf16 v[28:31], v[40:43], v[228:231], v[28:31]
    s_cbranch_vccnz L_f163
    s_waitcnt vmcnt(4)
L_f163:
    s_waitcnt vmcnt(6)
    buffer_load_dwordx4 v[100:103], v252, s[64:67], 0 offen offset:128 nt
    v_xor_b32 v252, 2638848, v3
    s_waitcnt lgkmcnt(0)
    v_cmp_lt_i32 vcc, 0, v250
    v_mov_b32 v249, 163
    ds_write_b32 v248, v249 offset:3296
    ds_read_b32 v250, v248 offset:3312
    s_cbranch_vccnz L_f164
    s_waitcnt vmcnt(4)
L_f164:
    s_waitcnt vmcnt(6)
    buffer_load_dwordx4 v[104:107], v252, s[64:67], 0 offen offset:0 nt
    s_cbranch_vccnz L_f165
    s_waitcnt vmcnt(4)
L_f165:
    s_waitcnt vmcnt(6)
    buffer_load_dwordx4 v[108:111], v252, s[64:67], 0 offen offset:128 nt
    v_xor_b32 v252, 2704384, v3
    s_waitcnt lgkmcnt(0)
    v_cmp_lt_i32 vcc, 0, v250
    v_mov_b32 v249, 165
    ds_write_b32 v248, v249 offset:3296
    ds_read_b32 v250, v248 offset:3312
    s_cbranch_vccnz L_f166
    s_waitcnt vmcnt(4)
L_f166:
    s_waitcnt vmcnt(6)
    buffer_load_dwordx4 v[112:115], v252, s[64:67], 0 offen offset:0 nt
    v_and_b32 v36, v55, v4
    v_and_b32 v37, v55, v5
    v_and_b32_dpp v38, v55, v6 row_half_mirror row_mask:0xf bank_mask:0xf
    v_and_b32_dpp v39, v55, v7 row_half_mirror row_mask:0xf bank_mask:0xf
    v_and_b32_dpp v40, v55, v4 row_half_mirror row_mask:0xf bank_mask:0xf
    v_and_b32_dpp v41, v55, v5 row_half_mirror row_mask:0xf bank_mask:0xf
    v_and_b32 v42, v55, v6
    v_and_b32 v43, v55, v7
    s_nop 1
    v_mfma_f32_16x16x32_bf16 v[24:27], v[36:39], v[232:235], v[24:27]
    v_mfma_f32_16x16x32_bf16 v[28:31], v[36:39], v[236:239], v[28:31]
    v_mfma_f32_16x16x32_bf16 v[24:27], v[40:43], v[240:243], v[24:27]
    v_mfma_f32_16x16x32_bf16 v[28:31], v[40:43], v[244:247], v[28:31]
    s_cbranch_vccnz L_f167
    s_waitcnt vmcnt(4)
L_f167:
    s_waitcnt vmcnt(6)
    buffer_load_dwordx4 v[116:119], v252, s[64:67], 0 offen offset:128 nt
    v_xor_b32 v252, 671744, v3
    s_waitcnt lgkmcnt(0)
    v_cmp_lt_i32 vcc, 0, v250
    v_mov_b32 v249, 167
    ds_write_b32 v248, v249 offset:3296
    ds_read_b32 v250, v248 offset:3312
    s_cbranch_vccnz L_f168
    s_waitcnt vmcnt(4)
L_f168:
    s_waitcnt vmcnt(6)
    buffer_load_dwordx4 v[120:123], v252, s[64:67], 0 offen offset:0 nt
    s_cbranch_vccnz L_f169
    s_waitcnt vmcnt(4)
L_f169:
    s_waitcnt vmcnt(6)
    buffer_load_dwordx4 v[124:127], v252, s[64:67], 0 offen offset:128 nt
    v_xor_b32 v252, 737280, v3
    s_waitcnt lgkmcnt(0)
    v_cmp_lt_i32 vcc, 0, v250
    v_mov_b32 v249, 169
    ds_write_b32 v248, v249 offset:3296
    ds_read_b32 v250, v248 offset:3312
    s_cbranch_vccnz L_f170
    s_waitcnt vmcnt(4)
L_f170:
    s_waitcnt vmcnt(6)
    buffer_load_dwordx4 v[128:131], v252, s[64:67], 0 offen offset:0 nt
    v_and_b32 v36, v56, v4
    v_and_b32 v37, v56, v5
    v_and_b32_dpp v38, v56, v6 row_half_mirror row_mask:0xf bank_mask:0xf
    v_and_b32_dpp v39, v56, v7 row_half_mirror row_mask:0xf bank_mask:0xf
    v_and_b32_dpp v40, v56, v4 row_half_mirror row_mask:0xf bank_mask:0xf
    v_and_b32_dpp v41, v56, v5 row_half_mirror row_mask:0xf bank_mask:0xf
    v_and_b32 v42, v56, v6
    v_and_b32 v43, v56, v7
    s_nop 1
    v_mfma_f32_16x16x32_bf16 v[24:27], v[36:39], v[88:91], v[24:27]
    v_mfma_f32_16x16x32_bf16 v[28:31], v[36:39], v[92:95], v[28:31]
    v_mfma_f32_16x16x32_bf16 v[24:27], v[40:43], v[96:99], v[24:27]
    v_mfma_f32_16x16x32_bf16 v[28:31], v[40:43], v[100:103], v[28:31]
    s_cbranch_vccnz L_f171
    s_waitcnt vmcnt(4)
L_f171:
    s_waitcnt vmcnt(6)
    buffer_load_dwordx4 v[132:135], v252, s[64:67], 0 offen offset:128 nt
    v_xor_b32 v252, 2768896, v3
    s_waitcnt lgkmcnt(0)
    v_cmp_lt_i32 vcc, 0, v250
    v_mov_b32 v249, 171
    ds_write_b32 v248, v249 offset:3296
    ds_read_b32 v250, v248 offset:3312
    s_cbranch_vccnz L_f172
    s_waitcnt vmcnt(4)
L_f172:
    s_waitcnt vmcnt(6)
    buffer_load_dwordx4 v[136:139], v252, s[64:67], 0 offen offset:0 nt
    s_cbranch_vccnz L_f173
    s_waitcnt vmcnt(4)
L_f173:
    s_waitcnt vmcnt(6)
    buffer_load_dwordx4 v[140:143], v252, s[64:67], 0 offen offset:128 nt
    v_xor_b32 v252, 2834432, v3
    s_waitcnt lgkmcnt(0)
    v_cmp_lt_i32 vcc, 0, v250
    v_mov_b32 v249, 173
    ds_write_b32 v248, v249 offset:3296
    ds_read_b32 v250, v248 offset:3312
    s_cbranch_vccnz L_f174
    s_waitcnt vmcnt(4)
L_f174:
    s_waitcnt vmcnt(6)
    buffer_load_dwordx4 v[144:147], v252, s[64:67], 0 offen offset:0 nt
    v_and_b32 v36, v57, v4
    v_and_b32 v37, v57, v5
    v_and_b32_dpp v38, v57, v6 row_half_mirror row_mask:0xf bank_mask:0xf
    v_and_b32_dpp v39, v57, v7 row_half_mirror row_mask:0xf bank_mask:0xf
    v_and_b32_dpp v40, v57, v4 row_half_mirror row_mask:0xf bank_mask:0xf
    v_and_b32_dpp v41, v57, v5 row_half_mirror row_mask:0xf bank_mask:0xf
    v_and_b32 v42, v57, v6
    v_and_b32 v43, v57, v7
    s_nop 1
    v_mfma_f32_16x16x32_bf16 v[24:27], v[36:39], v[104:107], v[24:27]
    v_mfma_f32_16x16x32_bf16 v[28:31], v[36:39], v[108:111], v[28:31]
    v_mfma_f32_16x16x32_bf16 v[24:27], v[40:43], v[112:115], v[24:27]
    v_mfma_f32_16x16x32_bf16 v[28:31], v[40:43], v[116:119], v[28:31]
    s_cbranch_vccnz L_f175
    s_waitcnt vmcnt(4)
L_f175:
    s_waitcnt vmcnt(6)
    buffer_load_dwordx4 v[148:151], v252, s[64:67], 0 offen offset:128 nt
    v_xor_b32 v252, 1594368, v3
    s_waitcnt lgkmcnt(0)
    v_cmp_lt_i32 vcc, 0, v250
    v_mov_b32 v249, 175
    ds_write_b32 v248, v249 offset:3296
    ds_read_b32 v250, v248 offset:3312
    s_cbranch_vccnz L_f176
    s_waitcnt vmcnt(4)
L_f176:
    s_waitcnt vmcnt(6)
    buffer_load_dwordx4 v[152:155], v252, s[64:67], 0 offen offset:0 nt
    s_cbranch_vccnz L_f177
    s_waitcnt vmcnt(4)
L_f177:
    s_waitcnt vmcnt(6)
    buffer_load_dwordx4 v[156:159], v252, s[64:67], 0 offen offset:128 nt
    v_xor_b32 v252, 1659904, v3
    s_waitcnt lgkmcnt(0)
    v_cmp_lt_i32 vcc, 0, v250
    v_mov_b32 v249, 177
    ds_write_b32 v248, v249 offset:3296
    ds_read_b32 v250, v248 offset:3312
    s_cbranch_vccnz L_f178
    s_waitcnt vmcnt(4)
L_f178:
    s_waitcnt vmcnt(6)
    buffer_load_dwordx4 v[160:163], v252, s[64:67], 0 offen offset:0 nt
    v_and_b32 v36, v58, v4
    v_and_b32 v37, v58, v5
    v_and_b32_dpp v38, v58, v6 row_half_mirror row_mask:0xf bank_mask:0xf
    v_and_b32_dpp v39, v58, v7 row_half_mirror row_mask:0xf bank_mask:0xf
    v_and_b32_dpp v40, v58, v4 row_half_mirror row_mask:0xf bank_mask:0xf
    v_and_b32_dpp v41, v58, v5 row_half_mirror row_mask:0xf bank_mask:0xf
    v_and_b32 v42, v58, v6
    v_and_b32 v43, v58, v7
    s_nop 1
    v_mfma_f32_16x16x32_bf16 v[24:27], v[36:39], v[120:123], v[24:27]
    v_mfma_f32_16x16x32_bf16 v[28:31], v[36:39], v[124:127], v[28:31]
    v_mfma_f32_16x16x32_bf16 v[24:27], v[40:43], v[128:131], v[24:27]
    v_mfma_f32_16x16x32_bf16 v[28:31], v[40:43], v[132:135], v[28:31]
    s_cbranch_vccnz L_f179
    s_waitcnt vmcnt(4)
L_f179:
    s_waitcnt vmcnt(6)
    buffer_load_dwordx4 v[164:167], v252, s[64:67], 0 offen offset:128 nt
    v_xor_b32 v252, 3691520, v3
    s_waitcnt lgkmcnt(0)
    v_cmp_lt_i32 vcc, 0, v250
    v_mov_b32 v249, 179
    ds_write_b32 v248, v249 offset:3296
    ds_read_b32 v250, v248 offset:3312
    s_cbranch_vccnz L_f180
    s_waitcnt vmcnt(4)
L_f180:
    s_waitcnt vmcnt(6)
    buffer_load_dwordx4 v[168:171], v252, s[64:67], 0 offen offset:0 nt
    s_cbranch_vccnz L_f181
    s_waitcnt vmcnt(4)
L_f181:
    s_waitcnt vmcnt(6)
    buffer_load_dwordx4 v[172:175], v252, s[64:67], 0 offen offset:128 nt
    v_xor_b32 v252, 3757056, v3
    s_waitcnt lgkmcnt(0)
    v_cmp_lt_i32 vcc, 0, v250
    v_mov_b32 v249, 181
    ds_write_b32 v248, v249 offset:3296
    ds_read_b32 v250, v248 offset:3312
    s_cbranch_vccnz L_f182
    s_waitcnt vmcnt(4)
L_f182:
    s_waitcnt vmcnt(6)
    buffer_load_dwordx4 v[176:179], v252, s[64:67], 0 offen offset:0 nt
    v_and_b32 v36, v59, v4
    v_and_b32 v37, v59, v5
    v_and_b32_dpp v38, v59, v6 row_half_mirror row_mask:0xf bank_mask:0xf
    v_and_b32_dpp v39, v59, v7 row_half_mirror row_mask:0xf bank_mask:0xf
    v_and_b32_dpp v40, v59, v4 row_half_mirror row_mask:0xf bank_mask:0xf
    v_and_b32_dpp v41, v59, v5 row_half_mirror row_mask:0xf bank_mask:0xf
    v_and_b32 v42, v59, v6
    v_and_b32 v43, v59, v7
    s_nop 1
    v_mfma_f32_16x16x32_bf16 v[24:27], v[36:39], v[136:139], v[24:27]
    v_mfma_f32_16x16x32_bf16 v[28:31], v[36:39], v[140:143], v[28:31]
    v_mfma_f32_16x16x32_bf16 v[24:27], v[40:43], v[144:147], v[24:27]
    v_mfma_f32_16x16x32_bf16 v[28:31], v[40:43], v[148:151], v[28:31]
    s_cbranch_vccnz L_f183
    s_waitcnt vmcnt(4)
L_f183:
    s_waitcnt vmcnt(6)
    buffer_load_dwordx4 v[180:183], v252, s[64:67], 0 offen offset:128 nt
    v_xor_b32 v252, 1724416, v3
    s_waitcnt lgkmcnt(0)
    v_cmp_lt_i32 vcc, 0, v250
    v_mov_b32 v249, 183
    ds_write_b32 v248, v249 offset:3296
    ds_read_b32 v250, v248 offset:3312
    s_cbranch_vccnz L_f184
    s_waitcnt vmcnt(4)
L_f184:
    s_waitcnt vmcnt(6)
    buffer_load_dwordx4 v[184:187], v252, s[64:67], 0 offen offset:0 nt
    s_cbranch_vccnz L_f185
    s_waitcnt vmcnt(4)
L_f185:
    s_waitcnt vmcnt(6)
    buffer_load_dwordx4 v[188:191], v252, s[64:67], 0 offen offset:128 nt
    v_xor_b32 v252, 1789952, v3
    s_waitcnt lgkmcnt(0)
    v_cmp_lt_i32 vcc, 0, v250
    v_mov_b32 v249, 185
    ds_write_b32 v248, v249 offset:3296
    ds_read_b32 v250, v248 offset:3312
    s_cbranch_vccnz L_f186
    s_waitcnt vmcnt(4)
L_f186:
    s_waitcnt vmcnt(6)
    buffer_load_dwordx4 v[192:195], v252, s[64:67], 0 offen offset:0 nt
    v_and_b32 v36, v60, v4
    v_and_b32 v37, v60, v5
    v_and_b32_dpp v38, v60, v6 row_half_mirror row_mask:0xf bank_mask:0xf
    v_and_b32_dpp v39, v60, v7 row_half_mirror row_mask:0xf bank_mask:0xf
    v_and_b32_dpp v40, v60, v4 row_half_mirror row_mask:0xf bank_mask:0xf
    v_and_b32_dpp v41, v60, v5 row_half_mirror row_mask:0xf bank_mask:0xf
    v_and_b32 v42, v60, v6
    v_and_b32 v43, v60, v7
    s_nop 1
    v_mfma_f32_16x16x32_bf16 v[24:27], v[36:39], v[152:155], v[24:27]
    v_mfma_f32_16x16x32_bf16 v[28:31], v[36:39], v[156:159], v[28:31]
    v_mfma_f32_16x16x32_bf16 v[24:27], v[40:43], v[160:163], v[24:27]
    v_mfma_f32_16x16x32_bf16 v[28:31], v[40:43], v[164:167], v[28:31]
    s_cbranch_vccnz L_f187
    s_waitcnt vmcnt(4)
L_f187:
    s_waitcnt vmcnt(6)
    buffer_load_dwordx4 v[196:199], v252, s[64:67], 0 offen offset:128 nt
    v_xor_b32 v252, 3821568, v3
    s_waitcnt lgkmcnt(0)
    v_cmp_lt_i32 vcc, 0, v250
    v_mov_b32 v249, 187
    ds_write_b32 v248, v249 offset:3296
    ds_read_b32 v250, v248 offset:3312
    s_cbranch_vccnz L_f188
    s_waitcnt vmcnt(4)
L_f188:
    s_waitcnt vmcnt(6)
    buffer_load_dwordx4 v[200:203], v252, s[64:67], 0 offen offset:0 nt
    s_cbranch_vccnz L_f189
    s_waitcnt vmcnt(4)
L_f189:
    s_waitcnt vmcnt(6)
    buffer_load_dwordx4 v[204:207], v252, s[64:67], 0 offen offset:128 nt
    v_xor_b32 v252, 3887104, v3
    s_waitcnt lgkmcnt(0)
    v_cmp_lt_i32 vcc, 0, v250
    v_mov_b32 v249, 189
    ds_write_b32 v248, v249 offset:3296
    ds_read_b32 v250, v248 offset:3312
    s_cbranch_vccnz L_f190
    s_waitcnt vmcnt(4)
L_f190:
    s_waitcnt vmcnt(6)
    buffer_load_dwordx4 v[208:211], v252, s[64:67], 0 offen offset:0 nt
    v_and_b32 v36, v61, v4
    v_and_b32 v37, v61, v5
    v_and_b32_dpp v38, v61, v6 row_half_mirror row_mask:0xf bank_mask:0xf
    v_and_b32_dpp v39, v61, v7 row_half_mirror row_mask:0xf bank_mask:0xf
    v_and_b32_dpp v40, v61, v4 row_half_mirror row_mask:0xf bank_mask:0xf
    v_and_b32_dpp v41, v61, v5 row_half_mirror row_mask:0xf bank_mask:0xf
    v_and_b32 v42, v61, v6
    v_and_b32 v43, v61, v7
    s_nop 1
    v_mfma_f32_16x16x32_bf16 v[24:27], v[36:39], v[168:171], v[24:27]
    v_mfma_f32_16x16x32_bf16 v[28:31], v[36:39], v[172:175], v[28:31]
    v_mfma_f32_16x16x32_bf16 v[24:27], v[40:43], v[176:179], v[24:27]
    v_mfma_f32_16x16x32_bf16 v[28:31], v[40:43], v[180:183], v[28:31]
    s_cbranch_vccnz L_f191
    s_waitcnt vmcnt(4)
L_f191:
    s_waitcnt vmcnt(6)
    buffer_load_dwordx4 v[212:215], v252, s[64:67], 0 offen offset:128 nt
    v_xor_b32 v252, 4194304, v3
    s_waitcnt lgkmcnt(0)
    v_cmp_lt_i32 vcc, 0, v250
    v_mov_b32 v249, 191
    ds_write_b32 v248, v249 offset:3296
    ds_read_b32 v250, v248 offset:3312
    s_cbranch_vccnz L_f192
    s_waitcnt vmcnt(4)
L_f192:
    s_waitcnt vmcnt(6)
    buffer_load_dwordx4 v[216:219], v252, s[64:67], 0 offen offset:0 nt
    s_cbranch_vccnz L_f193
    s_waitcnt vmcnt(4)
L_f193:
    s_waitcnt vmcnt(6)
    buffer_load_dwordx4 v[220:223], v252, s[64:67], 0 offen offset:128 nt
    v_xor_b32 v252, 4259840, v3
    s_waitcnt lgkmcnt(0)
    v_cmp_lt_i32 vcc, 0, v250
    v_mov_b32 v249, 193
    ds_write_b32 v248, v249 offset:3296
    ds_read_b32 v250, v248 offset:3312
    s_cbranch_vccnz L_f194
    s_waitcnt vmcnt(4)
L_f194:
    s_waitcnt vmcnt(6)
    buffer_load_dwordx4 v[224:227], v252, s[64:67], 0 offen offset:0 nt
    v_and_b32 v36, v62, v4
    v_and_b32 v37, v62, v5
    v_and_b32_dpp v38, v62, v6 row_half_mirror row_mask:0xf bank_mask:0xf
    v_and_b32_dpp v39, v62, v7 row_half_mirror row_mask:0xf bank_mask:0xf
    v_and_b32_dpp v40, v62, v4 row_half_mirror row_mask:0xf bank_mask:0xf
    v_and_b32_dpp v41, v62, v5 row_half_mirror row_mask:0xf bank_mask:0xf
    v_and_b32 v42, v62, v6
    v_and_b32 v43, v62, v7
    s_nop 1
    v_mfma_f32_16x16x32_bf16 v[24:27], v[36:39], v[184:187], v[24:27]
    v_mfma_f32_16x16x32_bf16 v[28:31], v[36:39], v[188:191], v[28:31]
    v_mfma_f32_16x16x32_bf16 v[24:27], v[40:43], v[192:195], v[24:27]
    v_mfma_f32_16x16x32_bf16 v[28:31], v[40:43], v[196:199], v[28:31]
    s_cbranch_vccnz L_f195
    s_waitcnt vmcnt(4)
L_f195:
    s_waitcnt vmcnt(6)
    buffer_load_dwordx4 v[228:231], v252, s[64:67], 0 offen offset:128 nt
    v_xor_b32 v252, 6291456, v3
    s_waitcnt lgkmcnt(0)
    v_cmp_lt_i32 vcc, 0, v250
    v_mov_b32 v249, 195
    ds_write_b32 v248, v249 offset:3296
    ds_read_b32 v250, v248 offset:3312
    s_cbranch_vccnz L_f196
    s_waitcnt vmcnt(4)
L_f196:
    s_waitcnt vmcnt(6)
    buffer_load_dwordx4 v[232:235], v252, s[64:67], 0 offen offset:0 nt
    s_cbranch_vccnz L_f197
    s_waitcnt vmcnt(4)
L_f197:
    s_waitcnt vmcnt(6)
    buffer_load_dwordx4 v[236:239], v252, s[64:67], 0 offen offset:128 nt
    v_xor_b32 v252, 6356992, v3
    s_waitcnt lgkmcnt(0)
    v_cmp_lt_i32 vcc, 0, v250
    v_mov_b32 v249, 197
    ds_write_b32 v248, v249 offset:3296
    ds_read_b32 v250, v248 offset:3312
    s_cbranch_vccnz L_f198
    s_waitcnt vmcnt(4)
L_f198:
    s_waitcnt vmcnt(6)
    buffer_load_dwordx4 v[240:243], v252, s[64:67], 0 offen offset:0 nt
    v_and_b32 v36, v63, v4
    v_and_b32 v37, v63, v5
    v_and_b32_dpp v38, v63, v6 row_half_mirror row_mask:0xf bank_mask:0xf
    v_and_b32_dpp v39, v63, v7 row_half_mirror row_mask:0xf bank_mask:0xf
    v_and_b32_dpp v40, v63, v4 row_half_mirror row_mask:0xf bank_mask:0xf
    v_and_b32_dpp v41, v63, v5 row_half_mirror row_mask:0xf bank_mask:0xf
    v_and_b32 v42, v63, v6
    v_and_b32 v43, v63, v7
    s_nop 1
    v_mfma_f32_16x16x32_bf16 v[24:27], v[36:39], v[200:203], v[24:27]
    v_mfma_f32_16x16x32_bf16 v[28:31], v[36:39], v[204:207], v[28:31]
    v_mfma_f32_16x16x32_bf16 v[24:27], v[40:43], v[208:211], v[24:27]
    v_mfma_f32_16x16x32_bf16 v[28:31], v[40:43], v[212:215], v[28:31]
    s_cbranch_vccnz L_f199
    s_waitcnt vmcnt(4)
L_f199:
    s_waitcnt vmcnt(6)
    buffer_load_dwordx4 v[244:247], v252, s[64:67], 0 offen offset:128 nt
    v_xor_b32 v252, 4326400, v3
    s_waitcnt lgkmcnt(0)
    v_cmp_lt_i32 vcc, 0, v250
    v_mov_b32 v249, 199
    ds_write_b32 v248, v249 offset:3296
    ds_read_b32 v250, v248 offset:3312
    s_cbranch_vccnz L_f200
    s_waitcnt vmcnt(4)
L_f200:
    s_waitcnt vmcnt(6)
    buffer_load_dwordx4 v[88:91], v252, s[64:67], 0 offen offset:0 nt
    s_cbranch_vccnz L_f201
    s_waitcnt vmcnt(4)
L_f201:
    s_waitcnt vmcnt(6)
    buffer_load_dwordx4 v[92:95], v252, s[64:67], 0 offen offset:128 nt
    v_xor_b32 v252, 4391936, v3
    s_waitcnt lgkmcnt(0)
    v_cmp_lt_i32 vcc, 0, v250
    v_mov_b32 v249, 201
    ds_write_b32 v248, v249 offset:3296
    ds_read_b32 v250, v248 offset:3312
    s_cbranch_vccnz L_f202
    s_waitcnt vmcnt(4)
L_f202:
    s_waitcnt vmcnt(6)
    buffer_load_dwordx4 v[96:99], v252, s[64:67], 0 offen offset:0 nt
    v_and_b32 v36, v64, v4
    v_and_b32 v37, v64, v5
    v_and_b32_dpp v38, v64, v6 row_half_mirror row_mask:0xf bank_mask:0xf
    v_and_b32_dpp v39, v64, v7 row_half_mirror row_mask:0xf bank_mask:0xf
    v_and_b32_dpp v40, v64, v4 row_half_mirror row_mask:0xf bank_mask:0xf
    v_and_b32_dpp v41, v64, v5 row_half_mirror row_mask:0xf bank_mask:0xf
    v_and_b32 v42, v64, v6
    v_and_b32 v43, v64, v7
    s_nop 1
    v_mfma_f32_16x16x32_bf16 v[24:27], v[36:39], v[216:219], v[24:27]
    v_mfma_f32_16x16x32_bf16 v[28:31], v[36:39], v[220:223], v[28:31]
    v_mfma_f32_16x16x32_bf16 v[24:27], v[40:43], v[224:227], v[24:27]
    v_mfma_f32_16x16x32_bf16 v[28:31], v[40:43], v[228:231], v[28:31]
    s_cbranch_vccnz L_f203
    s_waitcnt vmcnt(4)
L_f203:
    s_waitcnt vmcnt(6)
    buffer_load_dwordx4 v[100:103], v252, s[64:67], 0 offen offset:128 nt
    v_xor_b32 v252, 6423552, v3
    s_waitcnt lgkmcnt(0)
    v_cmp_lt_i32 vcc, 0, v250
    v_mov_b32 v249, 203
    ds_write_b32 v248, v249 offset:3296
    ds_read_b32 v250, v248 offset:3312
    s_cbranch_vccnz L_f204
    s_waitcnt vmcnt(4)
L_f204:
    s_waitcnt vmcnt(6)
    buffer_load_dwordx4 v[104:107], v252, s[64:67], 0 offen offset:0 nt
    s_cbranch_vccnz L_f205
    s_waitcnt vmcnt(4)
L_f205:
    s_waitcnt vmcnt(6)
    buffer_load_dwordx4 v[108:111], v252, s[64:67], 0 offen offset:128 nt
    v_xor_b32 v252, 6489088, v3
    s_waitcnt lgkmcnt(0)
    v_cmp_lt_i32 vcc, 0, v250
    v_mov_b32 v249, 205
    ds_write_b32 v248, v249 offset:3296
    ds_read_b32 v250, v248 offset:3312
    s_cbranch_vccnz L_f206
    s_waitcnt vmcnt(4)
L_f206:
    s_waitcnt vmcnt(6)
    buffer_load_dwordx4 v[112:115], v252, s[64:67], 0 offen offset:0 nt
    v_and_b32 v36, v65, v4
    v_and_b32 v37, v65, v5
    v_and_b32_dpp v38, v65, v6 row_half_mirror row_mask:0xf bank_mask:0xf
    v_and_b32_dpp v39, v65, v7 row_half_mirror row_mask:0xf bank_mask:0xf
    v_and_b32_dpp v40, v65, v4 row_half_mirror row_mask:0xf bank_mask:0xf
    v_and_b32_dpp v41, v65, v5 row_half_mirror row_mask:0xf bank_mask:0xf
    v_and_b32 v42, v65, v6
    v_and_b32 v43, v65, v7
    s_nop 1
    v_mfma_f32_16x16x32_bf16 v[24:27], v[36:39], v[232:235], v[24:27]
    v_mfma_f32_16x16x32_bf16 v[28:31], v[36:39], v[236:239], v[28:31]
    v_mfma_f32_16x16x32_bf16 v[24:27], v[40:43], v[240:243], v[24:27]
    v_mfma_f32_16x16x32_bf16 v[28:31], v[40:43], v[244:247], v[28:31]
    s_cbranch_vccnz L_f207
    s_waitcnt vmcnt(4)
L_f207:
    s_waitcnt vmcnt(6)
    buffer_load_dwordx4 v[116:119], v252, s[64:67], 0 offen offset:128 nt
    v_xor_b32 v252, 5246976, v3
    s_waitcnt lgkmcnt(0)
    v_cmp_lt_i32 vcc, 0, v250
    v_mov_b32 v249, 207
    ds_write_b32 v248, v249 offset:3296
    ds_read_b32 v250, v248 offset:3312
    s_cbranch_vccnz L_f208
    s_waitcnt vmcnt(4)
L_f208:
    s_waitcnt vmcnt(6)
    buffer_load_dwordx4 v[120:123], v252, s[64:67], 0 offen offset:0 nt
    s_cbranch_vccnz L_f209
    s_waitcnt vmcnt(4)
L_f209:
    s_waitcnt vmcnt(6)
    buffer_load_dwordx4 v[124:127], v252, s[64:67], 0 offen offset:128 nt
    v_xor_b32 v252, 5312512, v3
    s_waitcnt lgkmcnt(0)
    v_cmp_lt_i32 vcc, 0, v250
    v_mov_b32 v249, 209
    ds_write_b32 v248, v249 offset:3296
    ds_read_b32 v250, v248 offset:3312
    s_cbranch_vccnz L_f210
    s_waitcnt vmcnt(4)
L_f210:
    s_waitcnt vmcnt(6)
    buffer_load_dwordx4 v[128:131], v252, s[64:67], 0 offen offset:0 nt
    v_and_b32 v36, v66, v4
    v_and_b32 v37, v66, v5
    v_and_b32_dpp v38, v66, v6 row_half_mirror row_mask:0xf bank_mask:0xf
    v_and_b32_dpp v39, v66, v7 row_half_mirror row_mask:0xf bank_mask:0xf
    v_and_b32_dpp v40, v66, v4 row_half_mirror row_mask:0xf bank_mask:0xf
    v_and_b32_dpp v41, v66, v5 row_half_mirror row_mask:0xf bank_mask:0xf
    v_and_b32 v42, v66, v6
    v_and_b32 v43, v66, v7
    s_nop 1
    v_mfma_f32_16x16x32_bf16 v[24:27], v[36:39], v[88:91], v[24:27]
    v_mfma_f32_16x16x32_bf16 v[28:31], v[36:39], v[92:95], v[28:31]
    v_mfma_f32_16x16x32_bf16 v[24:27], v[40:43], v[96:99], v[24:27]
    v_mfma_f32_16x16x32_bf16 v[28:31], v[40:43], v[100:103], v[28:31]
    s_cbranch_vccnz L_f211
    s_waitcnt vmcnt(4)
L_f211:
    s_waitcnt vmcnt(6)
    buffer_load_dwordx4 v[132:135], v252, s[64:67], 0 offen offset:128 nt
    v_xor_b32 v252, 7344128, v3
    s_waitcnt lgkmcnt(0)
    v_cmp_lt_i32 vcc, 0, v250
    v_mov_b32 v249, 211
    ds_write_b32 v248, v249 offset:3296
    ds_read_b32 v250, v248 offset:3312
    s_cbranch_vccnz L_f212
    s_waitcnt vmcnt(4)
L_f212:
    s_waitcnt vmcnt(6)
    buffer_load_dwordx4 v[136:139], v252, s[64:67], 0 offen offset:0 nt
    s_cbranch_vccnz L_f213
    s_waitcnt vmcnt(4)
L_f213:
    s_waitcnt vmcnt(6)
    buffer_load_dwordx4 v[140:143], v252, s[64:67], 0 offen offset:128 nt
    v_xor_b32 v252, 7409664, v3
    s_waitcnt lgkmcnt(0)
    v_cmp_lt_i32 vcc, 0, v250
    v_mov_b32 v249, 213
    ds_write_b32 v248, v249 offset:3296
    ds_read_b32 v250, v248 offset:3312
    s_cbranch_vccnz L_f214
    s_waitcnt vmcnt(4)
L_f214:
    s_waitcnt vmcnt(6)
    buffer_load_dwordx4 v[144:147], v252, s[64:67], 0 offen offset:0 nt
    v_and_b32 v36, v67, v4
    v_and_b32 v37, v67, v5
    v_and_b32_dpp v38, v67, v6 row_half_mirror row_mask:0xf bank_mask:0xf
    v_and_b32_dpp v39, v67, v7 row_half_mirror row_mask:0xf bank_mask:0xf
    v_and_b32_dpp v40, v67, v4 row_half_mirror row_mask:0xf bank_mask:0xf
    v_and_b32_dpp v41, v67, v5 row_half_mirror row_mask:0xf bank_mask:0xf
    v_and_b32 v42, v67, v6
    v_and_b32 v43, v67, v7
    s_nop 1
    v_mfma_f32_16x16x32_bf16 v[24:27], v[36:39], v[104:107], v[24:27]
    v_mfma_f32_16x16x32_bf16 v[28:31], v[36:39], v[108:111], v[28:31]
    v_mfma_f32_16x16x32_bf16 v[24:27], v[40:43], v[112:115], v[24:27]
    v_mfma_f32_16x16x32_bf16 v[28:31], v[40:43], v[116:119], v[28:31]
    s_cbranch_vccnz L_f215
    s_waitcnt vmcnt(4)
L_f215:
    s_waitcnt vmcnt(6)
    buffer_load_dwordx4 v[148:151], v252, s[64:67], 0 offen offset:128 nt
    v_xor_b32 v252, 5379072, v3
    s_waitcnt lgkmcnt(0)
    v_cmp_lt_i32 vcc, 0, v250
    v_mov_b32 v249, 215
    ds_write_b32 v248, v249 offset:3296
    ds_read_b32 v250, v248 offset:3312
    s_cbranch_vccnz L_f216
    s_waitcnt vmcnt(4)
L_f216:
    s_waitcnt vmcnt(6)
    buffer_load_dwordx4 v[152:155], v252, s[64:67], 0 offen offset:0 nt
    s_cbranch_vccnz L_f217
    s_waitcnt vmcnt(4)
L_f217:
    s_waitcnt vmcnt(6)
    buffer_load_dwordx4 v[156:159], v252, s[64:67], 0 offen offset:128 nt
    v_xor_b32 v252, 5444608, v3
    s_waitcnt lgkmcnt(0)
    v_cmp_lt_i32 vcc, 0, v250
    v_mov_b32 v249, 217
    ds_write_b32 v248, v249 offset:3296
    ds_read_b32 v250, v248 offset:3312
    s_cbranch_vccnz L_f218
    s_waitcnt vmcnt(4)
L_f218:
    s_waitcnt vmcnt(6)
    buffer_load_dwordx4 v[160:163], v252, s[64:67], 0 offen offset:0 nt
    v_and_b32 v36, v68, v4
    v_and_b32 v37, v68, v5
    v_and_b32_dpp v38, v68, v6 row_half_mirror row_mask:0xf bank_mask:0xf
    v_and_b32_dpp v39, v68, v7 row_half_mirror row_mask:0xf bank_mask:0xf
    v_and_b32_dpp v40, v68, v4 row_half_mirror row_mask:0xf bank_mask:0xf
    v_and_b32_dpp v41, v68, v5 row_half_mirror row_mask:0xf bank_mask:0xf
    v_and_b32 v42, v68, v6
    v_and_b32 v43, v68, v7
    s_nop 1
    v_mfma_f32_16x16x32_bf16 v[24:27], v[36:39], v[120:123], v[24:27]
    v_mfma_f32_16x16x32_bf16 v[28:31], v[36:39], v[124:127], v[28:31]
    v_mfma_f32_16x16x32_bf16 v[24:27], v[40:43], v[128:131], v[24:27]
    v_mfma_f32_16x16x32_bf16 v[28:31], v[40:43], v[132:135], v[28:31]
    s_cbranch_vccnz L_f219
    s_waitcnt vmcnt(4)
L_f219:
    s_waitcnt vmcnt(6)
    buffer_load_dwordx4 v[164:167], v252, s[64:67], 0 offen offset:128 nt
    v_xor_b32 v252, 7476224, v3
    s_waitcnt lgkmcnt(0)
    v_cmp_lt_i32 vcc, 0, v250
    v_mov_b32 v249, 219
    ds_write_b32 v248, v249 offset:3296
    ds_read_b32 v250, v248 offset:3312
    s_cbranch_vccnz L_f220
    s_waitcnt vmcnt(4)
L_f220:
    s_waitcnt vmcnt(6)
    buffer_load_dwordx4 v[168:171], v252, s[64:67], 0 offen offset:0 nt
    s_cbranch_vccnz L_f221
    s_waitcnt vmcnt(4)
L_f221:
    s_waitcnt vmcnt(6)
    buffer_load_dwordx4 v[172:175], v252, s[64:67], 0 offen offset:128 nt
    v_xor_b32 v252, 7541760, v3
    s_waitcnt lgkmcnt(0)
    v_cmp_lt_i32 vcc, 0, v250
    v_mov_b32 v249, 221
    ds_write_b32 v248, v249 offset:3296
    ds_read_b32 v250, v248 offset:3312
    s_cbranch_vccnz L_f222
    s_waitcnt vmcnt(4)
L_f222:
    s_waitcnt vmcnt(6)
    buffer_load_dwordx4 v[176:179], v252, s[64:67], 0 offen offset:0 nt
    v_and_b32 v36, v69, v4
    v_and_b32 v37, v69, v5
    v_and_b32_dpp v38, v69, v6 row_half_mirror row_mask:0xf bank_mask:0xf
    v_and_b32_dpp v39, v69, v7 row_half_mirror row_mask:0xf bank_mask:0xf
    v_and_b32_dpp v40, v69, v4 row_half_mirror row_mask:0xf bank_mask:0xf
    v_and_b32_dpp v41, v69, v5 row_half_mirror row_mask:0xf bank_mask:0xf
    v_and_b32 v42, v69, v6
    v_and_b32 v43, v69, v7
    s_nop 1
    v_mfma_f32_16x16x32_bf16 v[24:27], v[36:39], v[136:139], v[24:27]
    v_mfma_f32_16x16x32_bf16 v[28:31], v[36:39], v[140:143], v[28:31]
    v_mfma_f32_16x16x32_bf16 v[24:27], v[40:43], v[144:147], v[24:27]
    v_mfma_f32_16x16x32_bf16 v[28:31], v[40:43], v[148:151], v[28:31]
    s_cbranch_vccnz L_f223
    s_waitcnt vmcnt(4)
L_f223:
    s_waitcnt vmcnt(6)
    buffer_load_dwordx4 v[180:183], v252, s[64:67], 0 offen offset:128 nt
    v_xor_b32 v252, 4736000, v3
    s_waitcnt lgkmcnt(0)
    v_cmp_lt_i32 vcc, 0, v250
    v_mov_b32 v249, 223
    ds_write_b32 v248, v249 offset:3296
    ds_read_b32 v250, v248 offset:3312
    s_cbranch_vccnz L_f224
    s_waitcnt vmcnt(4)
L_f224:
    s_waitcnt vmcnt(6)
    buffer_load_dwordx4 v[184:187], v252, s[64:67], 0 offen offset:0 nt
    s_cbranch_vccnz L_f225
    s_waitcnt vmcnt(4)
L_f225:
    s_waitcnt vmcnt(6)
    buffer_load_dwordx4 v[188:191], v252, s[64:67], 0 offen offset:128 nt
    v_xor_b32 v252, 4801536, v3
    s_waitcnt lgkmcnt(0)
    v_cmp_lt_i32 vcc, 0, v250
    v_mov_b32 v249, 225
    ds_write_b32 v248, v249 offset:3296
    ds_read_b32 v250, v248 offset:3312
    s_cbranch_vccnz L_f226
    s_waitcnt vmcnt(4)
L_f226:
    s_waitcnt vmcnt(6)
    buffer_load_dwordx4 v[192:195], v252, s[64:67], 0 offen offset:0 nt
    v_and_b32 v36, v70, v4
    v_and_b32 v37, v70, v5
    v_and_b32_dpp v38, v70, v6 row_half_mirror row_mask:0xf bank_mask:0xf
    v_and_b32_dpp v39, v70, v7 row_half_mirror row_mask:0xf bank_mask:0xf
    v_and_b32_dpp v40, v70, v4 row_half_mirror row_mask:0xf bank_mask:0xf
    v_and_b32_dpp v41, v70, v5 row_half_mirror row_mask:0xf bank_mask:0xf
    v_and_b32 v42, v70, v6
    v_and_b32 v43, v70, v7
    s_nop 1
    v_mfma_f32_16x16x32_bf16 v[24:27], v[36:39], v[152:155], v[24:27]
    v_mfma_f32_16x16x32_bf16 v[28:31], v[36:39], v[156:159], v[28:31]
    v_mfma_f32_16x16x32_bf16 v[24:27], v[40:43], v[160:163], v[24:27]
    v_mfma_f32_16x16x32_bf16 v[28:31], v[40:43], v[164:167], v[28:31]
    s_cbranch_vccnz L_f227
    s_waitcnt vmcnt(4)
L_f227:
    s_waitcnt vmcnt(6)
    buffer_load_dwordx4 v[196:199], v252, s[64:67], 0 offen offset:128 nt
    v_xor_b32 v252, 6833152, v3
    s_waitcnt lgkmcnt(0)
    v_cmp_lt_i32 vcc, 0, v250
    v_mov_b32 v249, 227
    ds_write_b32 v248, v249 offset:3296
    ds_read_b32 v250, v248 offset:3312
    s_cbranch_vccnz L_f228
    s_waitcnt vmcnt(4)
L_f228:
    s_waitcnt vmcnt(6)
    buffer_load_dwordx4 v[200:203], v252, s[64:67], 0 offen offset:0 nt
    s_cbranch_vccnz L_f229
    s_waitcnt vmcnt(4)
L_f229:
    s_waitcnt vmcnt(6)
    buffer_load_dwordx4 v[204:207], v252, s[64:67], 0 offen offset:128 nt
    v_xor_b32 v252, 6898688, v3
    s_waitcnt lgkmcnt(0)
    v_cmp_lt_i32 vcc, 0, v250
    v_mov_b32 v249, 229
    ds_write_b32 v248, v249 offset:3296
    ds_read_b32 v250, v248 offset:3312
    s_cbranch_vccnz L_f230
    s_waitcnt vmcnt(4)
L_f230:
    s_waitcnt vmcnt(6)
    buffer_load_dwordx4 v[208:211], v252, s[64:67], 0 offen offset:0 nt
    v_and_b32 v36, v71, v4
    v_and_b32 v37, v71, v5
    v_and_b32_dpp v38, v71, v6 row_half_mirror row_mask:0xf bank_mask:0xf
    v_and_b32_dpp v39, v71, v7 row_half_mirror row_mask:0xf bank_mask:0xf
    v_and_b32_dpp v40, v71, v4 row_half_mirror row_mask:0xf bank_mask:0xf
    v_and_b32_dpp v41, v71, v5 row_half_mirror row_mask:0xf bank_mask:0xf
    v_and_b32 v42, v71, v6
    v_and_b32 v43, v71, v7
    s_nop 1
    v_mfma_f32_16x16x32_bf16 v[24:27], v[36:39], v[168:171], v[24:27]
    v_mfma_f32_16x16x32_bf16 v[28:31], v[36:39], v[172:175], v[28:31]
    v_mfma_f32_16x16x32_bf16 v[24:27], v[40:43], v[176:179], v[24:27]
    v_mfma_f32_16x16x32_bf16 v[28:31], v[40:43], v[180:183], v[28:31]
    s_cbranch_vccnz L_f231
    s_waitcnt vmcnt(4)
L_f231:
    s_waitcnt vmcnt(6)
    buffer_load_dwordx4 v[212:215], v252, s[64:67], 0 offen offset:128 nt
    v_xor_b32 v252, 4866048, v3
    s_waitcnt lgkmcnt(0)
    v_cmp_lt_i32 vcc, 0, v250
    v_mov_b32 v249, 231
    ds_write_b32 v248, v249 offset:3296
    ds_read_b32 v250, v248 offset:3312
    s_cbranch_vccnz L_f232
    s_waitcnt vmcnt(4)
L_f232:
    s_waitcnt vmcnt(6)
    buffer_load_dwordx4 v[216:219], v252, s[64:67], 0 offen offset:0 nt
    s_cbranch_vccnz L_f233
    s_waitcnt vmcnt(4)
L_f233:
    s_waitcnt vmcnt(6)
    buffer_load_dwordx4 v[220:223], v252, s[64:67], 0 offen offset:128 nt
    v_xor_b32 v252, 4931584, v3
    s_waitcnt lgkmcnt(0)
    v_cmp_lt_i32 vcc, 0, v250
    v_mov_b32 v249, 233
    ds_write_b32 v248, v249 offset:3296
    ds_read_b32 v250, v248 offset:3312
    s_cbranch_vccnz L_f234
    s_waitcnt vmcnt(4)
L_f234:
    s_waitcnt vmcnt(6)
    buffer_load_dwordx4 v[224:227], v252, s[64:67], 0 offen offset:0 nt
    v_and_b32 v36, v72, v4
    v_and_b32 v37, v72, v5
    v_and_b32_dpp v38, v72, v6 row_half_mirror row_mask:0xf bank_mask:0xf
    v_and_b32_dpp v39, v72, v7 row_half_mirror row_mask:0xf bank_mask:0xf
    v_and_b32_dpp v40, v72, v4 row_half_mirror row_mask:0xf bank_mask:0xf
    v_and_b32_dpp v41, v72, v5 row_half_mirror row_mask:0xf bank_mask:0xf
    v_and_b32 v42, v72, v6
    v_and_b32 v43, v72, v7
    s_nop 1
    v_mfma_f32_16x16x32_bf16 v[24:27], v[36:39], v[184:187], v[24:27]
    v_mfma_f32_16x16x32_bf16 v[28:31], v[36:39], v[188:191], v[28:31]
    v_mfma_f32_16x16x32_bf16 v[24:27], v[40:43], v[192:195], v[24:27]
    v_mfma_f32_16x16x32_bf16 v[28:31], v[40:43], v[196:199], v[28:31]
    s_cbranch_vccnz L_f235
    s_waitcnt vmcnt(4)
L_f235:
    s_waitcnt vmcnt(6)
    buffer_load_dwordx4 v[228:231], v252, s[64:67], 0 offen offset:128 nt
    v_xor_b32 v252, 6963200, v3
    s_waitcnt lgkmcnt(0)
    v_cmp_lt_i32 vcc, 1, v250
    s_cbranch_vccnz L_b236
    v_cmp_lt_i32 vcc, 0, v250
    v_mov_b32 v249, 235
    ds_write_b32 v248, v249 offset:3296
    ds_read_b32 v250, v248 offset:3312
    s_cbranch_vccnz L_f236
    s_waitcnt vmcnt(4)
L_f236:
    s_waitcnt vmcnt(6)
    buffer_load_dwordx4 v[232:235], v252, s[64:67], 0 offen offset:0 nt
    s_waitcnt lgkmcnt(0)
    v_cmp_lt_i32 vcc, 1, v250
    s_cbranch_vccnz L_b237
    v_cmp_lt_i32 vcc, 0, v250
    v_mov_b32 v249, 236
    ds_write_b32 v248, v249 offset:3296
    ds_read_b32 v250, v248 offset:3312
    s_cbranch_vccnz L_f237
    s_waitcnt vmcnt(4)
L_f237:
    s_waitcnt vmcnt(6)
    buffer_load_dwordx4 v[236:239], v252, s[64:67], 0 offen offset:128 nt
    v_xor_b32 v252, 7028736, v3
    s_waitcnt lgkmcnt(0)
    v_cmp_lt_i32 vcc, 1, v250
    s_cbranch_vccnz L_b238
    v_cmp_lt_i32 vcc, 0, v250
    v_mov_b32 v249, 237
    ds_write_b32 v248, v249 offset:3296
    ds_read_b32 v250, v248 offset:3312
    s_cbranch_vccnz L_f238
    s_waitcnt vmcnt(4)
L_f238:
    s_waitcnt vmcnt(6)
    buffer_load_dwordx4 v[240:243], v252, s[64:67], 0 offen offset:0 nt
    s_waitcnt lgkmcnt(0)
    v_cmp_lt_i32 vcc, 1, v250
    s_cbranch_vccnz L_b239
    v_cmp_lt_i32 vcc, 0, v250
    v_mov_b32 v249, 238
    ds_write_b32 v248, v249 offset:3296
    ds_read_b32 v250, v248 offset:3312
    s_cbranch_vccnz L_f239
    s_waitcnt vmcnt(4)
L_f239:
    s_waitcnt vmcnt(6)
    buffer_load_dwordx4 v[244:247], v252, s[64:67], 0 offen offset:128 nt
    v_xor_b32 v252, 5788672, v3
    s_waitcnt lgkmcnt(0)
    v_cmp_lt_i32 vcc, 1, v250
    s_cbranch_vccnz L_b240
    v_cmp_lt_i32 vcc, 0, v250
    v_mov_b32 v249, 239
    ds_write_b32 v248, v249 offset:3296
    ds_read_b32 v250, v248 offset:3312
    s_cbranch_vccnz L_f240
    s_waitcnt vmcnt(4)
L_f240:
    s_waitcnt vmcnt(6)
    buffer_load_dwordx4 v[88:91], v252, s[64:67], 0 offen offset:0 nt
    s_waitcnt lgkmcnt(0)
    v_cmp_lt_i32 vcc, 1, v250
    s_cbranch_vccnz L_b241
    v_cmp_lt_i32 vcc, 0, v250
    v_mov_b32 v249, 240
    ds_write_b32 v248, v249 offset:3296
    ds_read_b32 v250, v248 offset:3312
    s_cbranch_vccnz L_f241
    s_waitcnt vmcnt(4)
L_f241:
    s_waitcnt vmcnt(6)
    buffer_load_dwordx4 v[92:95], v252, s[64:67], 0 offen offset:128 nt
    v_xor_b32 v252, 5854208, v3
    s_waitcnt lgkmcnt(0)
    v_cmp_lt_i32 vcc, 1, v250
    s_cbranch_vccnz L_b242
    v_cmp_lt_i32 vcc, 0, v250
    v_mov_b32 v249, 241
    ds_write_b32 v248, v249 offset:3296
    ds_read_b32 v250, v248 offset:3312
    s_cbranch_vccnz L_f242
    s_waitcnt vmcnt(4)
L_f242:
    s_waitcnt vmcnt(6)
    buffer_load_dwordx4 v[96:99], v252, s[64:67], 0 offen offset:0 nt
    s_waitcnt lgkmcnt(0)
    v_cmp_lt_i32 vcc, 1, v250
    s_cbranch_vccnz L_b243
    v_cmp_lt_i32 vcc, 0, v250
    v_mov_b32 v249, 242
    ds_write_b32 v248, v249 offset:3296
    ds_read_b32 v250, v248 offset:3312
    s_cbranch_vccnz L_f243
    s_waitcnt vmcnt(4)
L_f243:
    s_waitcnt vmcnt(6)
    buffer_load_dwordx4 v[100:103], v252, s[64:67], 0 offen offset:128 nt
    v_xor_b32 v252, 7885824, v3
    s_waitcnt lgkmcnt(0)
    v_cmp_lt_i32 vcc, 1, v250
    s_cbranch_vccnz L_b244
    v_cmp_lt_i32 vcc, 0, v250
    v_mov_b32 v249, 243
    ds_write_b32 v248, v249 offset:3296
    ds_read_b32 v250, v248 offset:3312
    s_cbranch_vccnz L_f244
    s_waitcnt vmcnt(4)
L_f244:
    s_waitcnt vmcnt(6)
    buffer_load_dwordx4 v[104:107], v252, s[64:67], 0 offen offset:0 nt
    s_waitcnt lgkmcnt(0)
    v_cmp_lt_i32 vcc, 1, v250
    s_cbranch_vccnz L_b245
    v_cmp_lt_i32 vcc, 0, v250
    v_mov_b32 v249, 244
    ds_write_b32 v248, v249 offset:3296
    ds_read_b32 v250, v248 offset:3312
    s_cbranch_vccnz L_f245
    s_waitcnt vmcnt(4)
L_f245:
    s_waitcnt vmcnt(6)
    buffer_load_dwordx4 v[108:111], v252, s[64:67], 0 offen offset:128 nt
    v_xor_b32 v252, 7951360, v3
    s_waitcnt lgkmcnt(0)
    v_cmp_lt_i32 vcc, 1, v250
    s_cbranch_vccnz L_b246
    v_cmp_lt_i32 vcc, 0, v250
    v_mov_b32 v249, 245
    ds_write_b32 v248, v249 offset:3296
    ds_read_b32 v250, v248 offset:3312
    s_cbranch_vccnz L_f246
    s_waitcnt vmcnt(4)
L_f246:
    s_waitcnt vmcnt(6)
    buffer_load_dwordx4 v[112:115], v252, s[64:67], 0 offen offset:0 nt
    s_waitcnt lgkmcnt(0)
    v_cmp_lt_i32 vcc, 1, v250
    s_cbranch_vccnz L_b247
    v_cmp_lt_i32 vcc, 0, v250
    v_mov_b32 v249, 246
    ds_write_b32 v248, v249 offset:3296
    ds_read_b32 v250, v248 offset:3312
    s_cbranch_vccnz L_f247
    s_waitcnt vmcnt(4)
L_f247:
    s_waitcnt vmcnt(6)
    buffer_load_dwordx4 v[116:119], v252, s[64:67], 0 offen offset:128 nt
    v_xor_b32 v252, 5918720, v3
    s_waitcnt lgkmcnt(0)
    v_cmp_lt_i32 vcc, 1, v250
    s_cbranch_vccnz L_b248
    v_cmp_lt_i32 vcc, 0, v250
    v_mov_b32 v249, 247
    ds_write_b32 v248, v249 offset:3296
    ds_read_b32 v250, v248 offset:3312
    s_cbranch_vccnz L_f248
    s_waitcnt vmcnt(4)
L_f248:
    s_waitcnt vmcnt(6)
    buffer_load_dwordx4 v[120:123], v252, s[64:67], 0 offen offset:0 nt
    s_waitcnt lgkmcnt(0)
    v_cmp_lt_i32 vcc, 1, v250
    s_cbranch_vccnz L_b249
    v_cmp_lt_i32 vcc, 0, v250
    v_mov_b32 v249, 248
    ds_write_b32 v248, v249 offset:3296
    ds_read_b32 v250, v248 offset:3312
    s_cbranch_vccnz L_f249
    s_waitcnt vmcnt(4)
L_f249:
    s_waitcnt vmcnt(6)
    buffer_load_dwordx4 v[124:127], v252, s[64:67], 0 offen offset:128 nt
    v_xor_b32 v252, 5984256, v3
    s_waitcnt lgkmcnt(0)
    v_cmp_lt_i32 vcc, 1, v250
    s_cbranch_vccnz L_b250
    v_cmp_lt_i32 vcc, 0, v250
    v_mov_b32 v249, 249
    ds_write_b32 v248, v249 offset:3296
    ds_read_b32 v250, v248 offset:3312
    s_cbranch_vccnz L_f250
    s_waitcnt vmcnt(4)
L_f250:
    s_waitcnt vmcnt(6)
    buffer_load_dwordx4 v[128:131], v252, s[64:67], 0 offen offset:0 nt
    s_waitcnt lgkmcnt(0)
    v_cmp_lt_i32 vcc, 1, v250
    s_cbranch_vccnz L_b251
    v_cmp_lt_i32 vcc, 0, v250
    v_mov_b32 v249, 250
    ds_write_b32 v248, v249 offset:3296
    ds_read_b32 v250, v248 offset:3312
    s_cbranch_vccnz L_f251
    s_waitcnt vmcnt(4)
L_f251:
    s_waitcnt vmcnt(6)
    buffer_load_dwordx4 v[132:135], v252, s[64:67], 0 offen offset:128 nt
    v_xor_b32 v252, 8015872, v3
    s_waitcnt lgkmcnt(0)
    v_cmp_lt_i32 vcc, 1, v250
    s_cbranch_vccnz L_b252
    v_cmp_lt_i32 vcc, 0, v250
    v_mov_b32 v249, 251
    ds_write_b32 v248, v249 offset:3296
    ds_read_b32 v250, v248 offset:3312
    s_cbranch_vccnz L_f252
    s_waitcnt vmcnt(4)
L_f252:
    s_waitcnt vmcnt(6)
    buffer_load_dwordx4 v[136:139], v252, s[64:67], 0 offen offset:0 nt
    s_waitcnt lgkmcnt(0)
    v_cmp_lt_i32 vcc, 1, v250
    s_cbranch_vccnz L_b253
    v_cmp_lt_i32 vcc, 0, v250
    v_mov_b32 v249, 252
    ds_write_b32 v248, v249 offset:3296
    ds_read_b32 v250, v248 offset:3312
    s_cbranch_vccnz L_f253
    s_waitcnt vmcnt(4)
L_f253:
    s_waitcnt vmcnt(6)
    buffer_load_dwordx4 v[140:143], v252, s[64:67], 0 offen offset:128 nt
    v_xor_b32 v252, 8081408, v3
    s_waitcnt lgkmcnt(0)
    v_cmp_lt_i32 vcc, 1, v250
    s_cbranch_vccnz L_b254
    v_cmp_lt_i32 vcc, 0, v250
    v_mov_b32 v249, 253
    ds_write_b32 v248, v249 offset:3296
    ds_read_b32 v250, v248 offset:3312
    s_cbranch_vccnz L_f254
    s_waitcnt vmcnt(4)
L_f254:
    s_waitcnt vmcnt(6)
    buffer_load_dwordx4 v[144:147], v252, s[64:67], 0 offen offset:0 nt
    s_waitcnt lgkmcnt(0)
    v_cmp_lt_i32 vcc, 1, v250
    s_cbranch_vccnz L_b255
    v_cmp_lt_i32 vcc, 0, v250
    v_mov_b32 v249, 254
    ds_write_b32 v248, v249 offset:3296
    ds_read_b32 v250, v248 offset:3312
    s_cbranch_vccnz L_f255
    s_waitcnt vmcnt(4)
L_f255:
    s_waitcnt vmcnt(6)
    buffer_load_dwordx4 v[148:151], v252, s[64:67], 0 offen offset:128 nt
    s_branch L_bjoin
L_b236:
    buffer_load_dwordx4 v[232:235], v252, s[64:67], 0 offen offset:0 nt
L_b237:
    buffer_load_dwordx4 v[236:239], v252, s[64:67], 0 offen offset:128 nt
    v_xor_b32 v252, 7028736, v3
L_b238:
    buffer_load_dwordx4 v[240:243], v252, s[64:67], 0 offen offset:0 nt
L_b239:
    buffer_load_dwordx4 v[244:247], v252, s[64:67], 0 offen offset:128 nt
    v_xor_b32 v252, 5788672, v3
L_b240:
    buffer_load_dwordx4 v[88:91], v252, s[64:67], 0 offen offset:0 nt
L_b241:
    buffer_load_dwordx4 v[92:95], v252, s[64:67], 0 offen offset:128 nt
    v_xor_b32 v252, 5854208, v3
L_b242:
    buffer_load_dwordx4 v[96:99], v252, s[64:67], 0 offen offset:0 nt
L_b243:
    buffer_load_dwordx4 v[100:103], v252, s[64:67], 0 offen offset:128 nt
    v_xor_b32 v252, 7885824, v3
L_b244:
    buffer_load_dwordx4 v[104:107], v252, s[64:67], 0 offen offset:0 nt
L_b245:
    buffer_load_dwordx4 v[108:111], v252, s[64:67], 0 offen offset:128 nt
    v_xor_b32 v252, 7951360, v3
L_b246:
    buffer_load_dwordx4 v[112:115], v252, s[64:67], 0 offen offset:0 nt
L_b247:
    buffer_load_dwordx4 v[116:119], v252, s[64:67], 0 offen offset:128 nt
    v_xor_b32 v252, 5918720, v3
L_b248:
    buffer_load_dwordx4 v[120:123], v252, s[64:67], 0 offen offset:0 nt
L_b249:
    buffer_load_dwordx4 v[124:127], v252, s[64:67], 0 offen offset:128 nt
    v_xor_b32 v252, 5984256, v3
L_b250:
    buffer_load_dwordx4 v[128:131], v252, s[64:67], 0 offen offset:0 nt
L_b251:
    buffer_load_dwordx4 v[132:135], v252, s[64:67], 0 offen offset:128 nt
    v_xor_b32 v252, 8015872, v3
L_b252:
    buffer_load_dwordx4 v[136:139], v252, s[64:67], 0 offen offset:0 nt
L_b253:
    buffer_load_dwordx4 v[140:143], v252, s[64:67], 0 offen offset:128 nt
    v_xor_b32 v252, 8081408, v3
L_b254:
    buffer_load_dwordx4 v[144:147], v252, s[64:67], 0 offen offset:0 nt
L_b255:
    buffer_load_dwordx4 v[148:151], v252, s[64:67], 0 offen offset:128 nt
L_bjoin:
    v_mov_b32 v249, 256
    ds_write_b32 v248, v249 offset:3296
    v_and_b32 v36, v73, v4
    v_and_b32 v37, v73, v5
    v_and_b32_dpp v38, v73, v6 row_half_mirror row_mask:0xf bank_mask:0xf
    v_and_b32_dpp v39, v73, v7 row_half_mirror row_mask:0xf bank_mask:0xf
    v_and_b32_dpp v40, v73, v4 row_half_mirror row_mask:0xf bank_mask:0xf
    v_and_b32_dpp v41, v73, v5 row_half_mirror row_mask:0xf bank_mask:0xf
    v_and_b32 v42, v73, v6
    v_and_b32 v43, v73, v7
    s_nop 1
    v_mfma_f32_16x16x32_bf16 v[24:27], v[36:39], v[200:203], v[24:27]
    s_waitcnt vmcnt(26)
    v_mfma_f32_16x16x32_bf16 v[28:31], v[36:39], v[204:207], v[28:31]
    s_waitcnt vmcnt(25)
    v_mfma_f32_16x16x32_bf16 v[24:27], v[40:43], v[208:211], v[24:27]
    s_waitcnt vmcnt(24)
    v_mfma_f32_16x16x32_bf16 v[28:31], v[40:43], v[212:215], v[28:31]
    v_and_b32 v36, v74, v4
    v_and_b32 v37, v74, v5
    v_and_b32_dpp v38, v74, v6 row_half_mirror row_mask:0xf bank_mask:0xf
    v_and_b32_dpp v39, v74, v7 row_half_mirror row_mask:0xf bank_mask:0xf
    v_and_b32_dpp v40, v74, v4 row_half_mirror row_mask:0xf bank_mask:0xf
    v_and_b32_dpp v41, v74, v5 row_half_mirror row_mask:0xf bank_mask:0xf
    v_and_b32 v42, v74, v6
    v_and_b32 v43, v74, v7
    s_nop 1
    s_waitcnt vmcnt(23)
    v_mfma_f32_16x16x32_bf16 v[24:27], v[36:39], v[216:219], v[24:27]
    s_waitcnt vmcnt(22)
    v_mfma_f32_16x16x32_bf16 v[28:31], v[36:39], v[220:223], v[28:31]
    s_waitcnt vmcnt(21)
    v_mfma_f32_16x16x32_bf16 v[24:27], v[40:43], v[224:227], v[24:27]
    s_waitcnt vmcnt(20)
    v_mfma_f32_16x16x32_bf16 v[28:31], v[40:43], v[228:231], v[28:31]
    v_and_b32 v36, v75, v4
    v_and_b32 v37, v75, v5
    v_and_b32_dpp v38, v75, v6 row_half_mirror row_mask:0xf bank_mask:0xf
    v_and_b32_dpp v39, v75, v7 row_half_mirror row_mask:0xf bank_mask:0xf
    v_and_b32_dpp v40, v75, v4 row_half_mirror row_mask:0xf bank_mask:0xf
    v_and_b32_dpp v41, v75, v5 row_half_mirror row_mask:0xf bank_mask:0xf
    v_and_b32 v42, v75, v6
    v_and_b32 v43, v75, v7
    s_nop 1
    s_waitcnt vmcnt(19)
    v_mfma_f32_16x16x32_bf16 v[24:27], v[36:39], v[232:235], v[24:27]
    s_waitcnt vmcnt(18)
    v_mfma_f32_16x16x32_bf16 v[28:31], v[36:39], v[236:239], v[28:31]
    s_waitcnt vmcnt(17)
    v_mfma_f32_16x16x32_bf16 v[24:27], v[40:43], v[240:243], v[24:27]
    s_waitcnt vmcnt(16)
    v_mfma_f32_16x16x32_bf16 v[28:31], v[40:43], v[244:247], v[28:31]
    v_and_b32 v36, v76, v4
    v_and_b32 v37, v76, v5
    v_and_b32_dpp v38, v76, v6 row_half_mirror row_mask:0xf bank_mask:0xf
    v_and_b32_dpp v39, v76, v7 row_half_mirror row_mask:0xf bank_mask:0xf
    v_and_b32_dpp v40, v76, v4 row_half_mirror row_mask:0xf bank_mask:0xf
    v_and_b32_dpp v41, v76, v5 row_half_mirror row_mask:0xf bank_mask:0xf
    v_and_b32 v42, v76, v6
    v_and_b32 v43, v76, v7
    s_nop 1
    s_waitcnt vmcnt(15)
    v_mfma_f32_16x16x32_bf16 v[24:27], v[36:39], v[88:91], v[24:27]
    s_waitcnt vmcnt(14)
    v_mfma_f32_16x16x32_bf16 v[28:31], v[36:39], v[92:95], v[28:31]
    s_waitcnt vmcnt(13)
    v_mfma_f32_16x16x32_bf16 v[24:27], v[40:43], v[96:99], v[24:27]
    s_waitcnt vmcnt(12)
    v_mfma_f32_16x16x32_bf16 v[28:31], v[40:43], v[100:103], v[28:31]
    v_and_b32 v36, v77, v4
    v_and_b32 v37, v77, v5
    v_and_b32_dpp v38, v77, v6 row_half_mirror row_mask:0xf bank_mask:0xf
    v_and_b32_dpp v39, v77, v7 row_half_mirror row_mask:0xf bank_mask:0xf
    v_and_b32_dpp v40, v77, v4 row_half_mirror row_mask:0xf bank_mask:0xf
    v_and_b32_dpp v41, v77, v5 row_half_mirror row_mask:0xf bank_mask:0xf
    v_and_b32 v42, v77, v6
    v_and_b32 v43, v77, v7
    s_nop 1
    s_waitcnt vmcnt(11)
    v_mfma_f32_16x16x32_bf16 v[24:27], v[36:39], v[104:107], v[24:27]
    s_waitcnt vmcnt(10)
    v_mfma_f32_16x16x32_bf16 v[28:31], v[36:39], v[108:111], v[28:31]
    s_waitcnt vmcnt(9)
    v_mfma_f32_16x16x32_bf16 v[24:27], v[40:43], v[112:115], v[24:27]
    s_waitcnt vmcnt(8)
    v_mfma_f32_16x16x32_bf16 v[28:31], v[40:43], v[116:119], v[28:31]
    v_and_b32 v36, v78, v4
    v_and_b32 v37, v78, v5
    v_and_b32_dpp v38, v78, v6 row_half_mirror row_mask:0xf bank_mask:0xf
    v_and_b32_dpp v39, v78, v7 row_half_mirror row_mask:0xf bank_mask:0xf
    v_and_b32_dpp v40, v78, v4 row_half_mirror row_mask:0xf bank_mask:0xf
    v_and_b32_dpp v41, v78, v5 row_half_mirror row_mask:0xf bank_mask:0xf
    v_and_b32 v42, v78, v6
    v_and_b32 v43, v78, v7
    s_nop 1
    s_waitcnt vmcnt(7)
    v_mfma_f32_16x16x32_bf16 v[24:27], v[36:39], v[120:123], v[24:27]
    s_waitcnt vmcnt(6)
    v_mfma_f32_16x16x32_bf16 v[28:31], v[36:39], v[124:127], v[28:31]
    s_waitcnt vmcnt(5)
    v_mfma_f32_16x16x32_bf16 v[24:27], v[40:43], v[128:131], v[24:27]
    s_waitcnt vmcnt(4)
    v_mfma_f32_16x16x32_bf16 v[28:31], v[40:43], v[132:135], v[28:31]
    v_and_b32 v36, v79, v4
    v_and_b32 v37, v79, v5
    v_and_b32_dpp v38, v79, v6 row_half_mirror row_mask:0xf bank_mask:0xf
    v_and_b32_dpp v39, v79, v7 row_half_mirror row_mask:0xf bank_mask:0xf
    v_and_b32_dpp v40, v79, v4 row_half_mirror row_mask:0xf bank_mask:0xf
    v_and_b32_dpp v41, v79, v5 row_half_mirror row_mask:0xf bank_mask:0xf
    v_and_b32 v42, v79, v6
    v_and_b32 v43, v79, v7
    s_nop 1
    s_waitcnt vmcnt(3)
    v_mfma_f32_16x16x32_bf16 v[24:27], v[36:39], v[136:139], v[24:27]
    s_waitcnt vmcnt(2)
    v_mfma_f32_16x16x32_bf16 v[28:31], v[36:39], v[140:143], v[28:31]
    s_waitcnt vmcnt(1)
    v_mfma_f32_16x16x32_bf16 v[24:27], v[40:43], v[144:147], v[24:27]
    s_waitcnt vmcnt(0)
    v_mfma_f32_16x16x32_bf16 v[28:31], v[40:43], v[148:151], v[28:31]
    s_cmp_lg_u32 s15, 0
    s_nop 5
    ds_write_b128 v82, v[24:27] offset:8192
    ds_write_b128 v82, v[28:31] offset:8448
    s_waitcnt lgkmcnt(0)
    s_barrier
    ds_read_b128 v[32:35], v80 offset:3200
    ds_read_b64 v[36:37], v83 offset:8192
    ds_read_b64 v[38:39], v83 offset:10240
    ds_read_b64 v[40:41], v83 offset:12288
    ds_read_b64 v[42:43], v83 offset:14336
    s_waitcnt lgkmcnt(3)
    v_mul_f32 v44, v32, v36
    v_mul_f32 v45, v32, v37
    s_waitcnt lgkmcnt(2)
    v_fmac_f32 v44, v33, v38
    v_fmac_f32 v45, v33, v39
    s_waitcnt lgkmcnt(1)
    v_fmac_f32 v44, v34, v40
    v_fmac_f32 v45, v34, v41
    s_waitcnt lgkmcnt(0)
    v_fmac_f32 v44, v35, v42
    v_fmac_f32 v45, v35, v43
    v_cvt_pk_bf16_f32 v24, v44, v45
    v_min_u32 v24, -2, v24
    s_nop 1
    v_mov_b32_dpp v25, v24 quad_perm:[1,1,1,1] row_mask:0xf bank_mask:0xf
    v_mov_b32_dpp v26, v24 quad_perm:[2,2,2,2] row_mask:0xf bank_mask:0xf
    v_mov_b32_dpp v27, v24 quad_perm:[3,3,3,3] row_mask:0xf bank_mask:0xf
    s_mov_b64 exec, s[46:47]
    s_cbranch_scc1 L_p1_wt
    buffer_store_dwordx4 v[24:27], v84, s[56:59], 0 offen
L_p1_stored:
    s_mov_b64 exec, -1
    s_cmp_ge_u32 s7, 28
    s_cbranch_scc1 L_stream_done
    buffer_load_dwordx4 v[64:67], v85, s[56:59], 0 offen sc1
    buffer_load_dwordx4 v[68:71], v85, s[56:59], 0 offen offset:1024 sc1
    buffer_load_dwordx4 v[72:75], v85, s[56:59], s45 offen sc1
    buffer_load_dwordx4 v[76:79], v85, s[56:59], s45 offen offset:1024 sc1
    ds_read_b32 v38, v253 offset:3328
    v_mov_b32 v39, 0x403f0000
    s_mov_b32 s11, 3200024
    s_branch L_p1_b
L_poll_p1:
    s_sub_u32 s11, s11, 1
    s_cbranch_scc1 L_p1_giveup
    s_mov_b64 exec, s[68:69]
    s_cbranch_execz L_p1_a
    buffer_load_dwordx4 v[64:67], v85, s[56:59], 0 offen sc1
    buffer_load_dwordx4 v[68:71], v85, s[56:59], 0 offen offset:1024 sc1
L_p1_a:
    s_mov_b64 exec, s[70:71]
    s_cbranch_execz L_p1_b
    buffer_load_dwordx4 v[72:75], v85, s[56:59], s45 offen sc1
    buffer_load_dwordx4 v[76:79], v85, s[56:59], s45 offen offset:1024 sc1
L_p1_b:
    s_mov_b64 exec, -1
    ds_read_b32 v37, v81 offset:3280
    ds_read_b64_tr_b16 v[48:49], v86 offset:49152
    ds_read_b64_tr_b16 v[50:51], v86 offset:49664
    ds_read_b64_tr_b16 v[52:53], v86 offset:49184
    ds_read_b64_tr_b16 v[54:55], v86 offset:49696
    ds_read_b64_tr_b16 v[56:57], v86 offset:53248
    ds_read_b64_tr_b16 v[58:59], v86 offset:53760
    ds_read_b64_tr_b16 v[60:61], v86 offset:53280
    ds_read_b64_tr_b16 v[62:63], v86 offset:53792
    s_waitcnt vmcnt(0)
    v_max_u32 v44, v64, v68
    v_max_u32 v45, v72, v76
    v_cmp_eq_u32 s[68:69], -1, v44
    v_cmp_eq_u32 s[70:71], -1, v45
    s_waitcnt lgkmcnt(0)
    v_cmp_eq_u32 vcc, 0, v37
    s_or_b64 s[72:73], s[68:69], s[70:71]
    s_or_b64 s[72:73], s[72:73], vcc
    s_cbranch_scc1 L_poll_p1
    v_mfma_f32_16x16x32_bf16 v[8:11], v[64:67], v[48:51], 0
    v_max3_u32 v44, v65, v66, v67
    v_mfma_f32_16x16x32_bf16 v[8:11], v[68:71], v[56:59], v[8:11]
    v_max3_u32 v45, v73, v74, v75
    v_mfma_f32_16x16x32_bf16 v[12:15], v[64:67], v[52:55], 0
    v_max3_u32 v44, v44, v69, v70
    v_mfma_f32_16x16x32_bf16 v[12:15], v[68:71], v[60:63], v[12:15]
    v_max3_u32 v45, v45, v77, v78
    v_mfma_f32_16x16x32_bf16 v[16:19], v[72:75], v[48:51], 0
    v_max_u32 v44, v44, v71
    v_mfma_f32_16x16x32_bf16 v[16:19], v[76:79], v[56:59], v[16:19]
    v_max_u32 v45, v45, v79
    v_mfma_f32_16x16x32_bf16 v[20:23], v[72:75], v[52:55], 0
    v_cmp_eq_u32 s[68:69], -1, v44
    v_mfma_f32_16x16x32_bf16 v[20:23], v[76:79], v[60:63], v[20:23]
    v_cmp_eq_u32 s[70:71], -1, v45
    s_or_b64 s[72:73], s[68:69], s[70:71]
    s_cbranch_scc1 L_poll_p1
    v_pk_add_f32 v[8:9], v[8:9], v[10:11]
    v_pk_add_f32 v[12:13], v[12:13], v[14:15]
    v_add_f32 v8, v8, v9
    v_add_f32 v12, v12, v13
    v_pk_add_f32 v[16:17], v[16:17], v[18:19]
    v_add_f32 v16, v16, v17
    v_pk_add_f32 v[20:21], v[20:21], v[22:23]
    v_add_f32 v20, v20, v21
    v_permlane32_swap_b32 v8, v16
    s_nop 0
    v_permlane32_swap_b32 v12, v20
    v_add_f32 v8, v8, v16
    v_add_f32 v12, v12, v20
    s_nop 1
    v_permlane16_swap_b32 v8, v12
    s_nop 0
    v_add_f32 v8, v8, v12
    v_min_u32 v8, -2, v8
    ds_wrxchg_rtn_b32 v9, v87, v8 offset:5120
    s_waitcnt lgkmcnt(0)
    v_cmp_ne_u32 vcc, -1, v9
    v_add_f32 v8, v8, v9
    v_add_f32 v8, v8, v38
    s_mov_b64 exec, vcc
    s_cbranch_vccz L_stream_done
    v_cndmask_b32 v12, v8, 1.0, s[74:75]
    v_cndmask_b32 v13, 1.0, v8, s[74:75]
    v_cvt_f64_f32 v[16:17], v12
    v_cvt_f64_f32 v[18:19], v13
    buffer_atomic_add_f64 v[16:17], v254, s[56:59], 0 offen sc0
    buffer_atomic_add_f64 v[18:19], v254, s[56:59], 0 offen offset:1024 sc0
    v_cvt_f64_f32 v[10:11], v8
    v_mov_b32 v23, s12
    s_waitcnt vmcnt(0)
    v_cndmask_b32 v20, v19, v17, s[74:75]
    v_cndmask_b32 v14, v16, v18, s[74:75]
    v_cndmask_b32 v15, v17, v19, s[74:75]
    v_mov_b32_dpp v22, v20 quad_perm:[1,0,3,2] row_mask:0xf bank_mask:0xf
    v_add_f64 v[10:11], v[10:11], v[14:15]
    v_cmp_eq_u32 vcc, v22, v39
    v_cvt_f32_f64 v8, v[10:11]
    v_cvt_pk_bf16_f32 v8, v8, v8
    s_mov_b64 exec, vcc
    s_cbranch_execz L_stream_done
    buffer_store_short v8, v255, s[60:63], 0 offen
    s_cmp_lg_u32 s14, 0
    s_cbranch_scc1 L_stream_done
    s_and_b64 exec, exec, 1
    s_cbranch_execz L_stream_done
    buffer_store_dword v23, v81, s[56:59], 0 offen
L_p1_giveup:
L_stream_done:
    s_endpgm
L_p1_wt:
    buffer_store_dwordx4 v[24:27], v84, s[56:59], 0 offen sc1
    s_branch L_p1_stored
L_helpers:
    s_cmp_eq_u32 s3, 5
    s_cbranch_scc1 L_control
    v_lshlrev_b32 v2, 4, v1
    s_and_b32 s13, s7, 3
    s_lshr_b32 s14, s7, 2
    s_mov_b32 m0, 4096
    s_waitcnt lgkmcnt(0)
    s_load_dword s46, s[40:41], 0
    s_mov_b32 s56, s40
    s_and_b32 s57, s41, 0xffff
    s_mov_b32 s58, 925696
    s_mov_b32 s59, 0x20000
    s_mov_b32 s60, s34
    s_and_b32 s61, s35, 0xffff
    s_mov_b32 s62, 896
    s_mov_b32 s63, 0x20000
    buffer_load_dwordx4 v2, s[60:63], 0 offen lds
    s_getreg_b32 s47, hwreg(HW_REG_XCC_ID, 0, 3)
    v_and_b32 v4, 1, v1
    v_mul_u32_u24 v6, 896, v4
    v_lshrrev_b32 v5, 4, v1
    v_lshl_add_u32 v6, v5, 4, v6
    v_lshlrev_b32 v7, 10, v5
    v_bfe_u32 v4, v1, 2, 2
    v_lshl_add_u32 v7, v4, 7, v7
    v_and_b32 v4, 3, v1
    v_lshl_add_u32 v7, v4, 3, v7
    s_mul_i32 s12, s13, 224
    v_add_u32 v130, s12, v6
    v_lshlrev_b32 v4, 3, v5
    v_sub_u32 v131, v130, v4
    v_lshlrev_b32 v4, 9, v5
    v_sub_u32 v132, v7, v4
    v_bfe_u32 v4, v1, 1, 2
    v_cmp_eq_u32 vcc, 0, v4
    s_nop 1
    v_cndmask_b32 v136, 0, -1, vcc
    v_cmp_eq_u32 vcc, 1, v4
    s_nop 1
    v_cndmask_b32 v137, 0, -1, vcc
    v_cmp_eq_u32 vcc, 2, v4
    s_nop 1
    v_cndmask_b32 v138, 0, -1, vcc
    v_cmp_eq_u32 vcc, 3, v4
    s_nop 1
    v_cndmask_b32 v139, 0, -1, vcc
    v_lshlrev_b32 v126, 6, v4
    v_lshl_add_u32 v126, v5, 4, v126
    v_and_b32 v4, 1, v1
    v_lshl_add_u32 v126, v4, 13, v126
    s_lshl_b32 s11, s6, 14
    s_lshl_b32 s12, s13, 11
    s_add_u32 s11, s11, s12
    s_lshl_b32 s12, s14, 8
    s_add_u32 s11, s11, s12
    s_add_u32 s11, s11, 262144
    v_add_u32 v126, s11, v126
    s_add_u32 s12, s11, 0
    s_load_dword s48, s[40:41], s12
    s_add_u32 s12, s11, 64
    s_load_dword s49, s[40:41], s12
    s_add_u32 s12, s11, 128
    s_load_dword s50, s[40:41], s12
    s_add_u32 s12, s11, 192
    s_load_dword s51, s[40:41], s12
    s_add_u32 s12, s11, 8192
    s_load_dword s52, s[40:41], s12
    s_add_u32 s12, s11, 8256
    s_load_dword s53, s[40:41], s12
    s_add_u32 s12, s11, 8320
    s_load_dword s54, s[40:41], s12
    s_add_u32 s12, s11, 8384
    s_load_dword s55, s[40:41], s12
    s_lshl_b32 s11, s6, 1
    s_add_u32 s11, s11, s8
    s_lshl_b32 s11, s11, 13
    s_add_u32 s11, s11, 262144
    v_add_u32 v127, s11, v2
    s_waitcnt lgkmcnt(0)
    s_and_b32 s11, s46, 0x7f7f7f7f
    s_add_u32 s11, s11, 0x35476b1d
    s_and_b32 s46, s46, 0x80808080
    s_xor_b32 s46, s46, s11
    s_and_b32 s68, s46, 0xff
    s_bfe_u32 s69, s46, 0x80008
    s_bfe_u32 s70, s46, 0x80010
    s_lshr_b32 s71, s46, 24
    s_lshl_b32 s11, s47, 8
    s_or_b32 s72, s68, s11
    s_mov_b32 s42, 0x0c0c0400
    s_mov_b32 s45, 0x04000c0c
    s_mov_b32 s43, 0x3db8aa3b
    v_mov_b32 v140, 0xff
    v_mov_b32 v141, 0x7ff
    s_barrier
    s_lshl_b32 s11, s6, 8
    s_add_u32 s11, s11, 12288
    s_lshl_b32 s12, s7, 2
    s_add_u32 s11, s11, s12
    v_mov_b32 v124, 80
    v_mov_b32 v125, 0
    s_mov_b64 exec, 1
    buffer_store_dword v124, v125, s[56:59], s11 offen
    s_cmp_lg_u32 s7, 31
    s_cbranch_scc1 L_c_nz
    buffer_store_dword v125, v125, s[56:59], s11 offen offset:4
L_c_nz:
    s_mov_b64 exec, -1
    ds_read_b128 v[144:147], v130 offset:0
    ds_read_b128 v[148:151], v130 offset:64
    ds_read_b128 v[152:155], v130 offset:128
    ds_read_b64 v[156:157], v131 offset:192
    v_mov_b32 v174, 0
    v_mov_b32 v22, 0
    v_mov_b32 v175, 0
    v_mov_b32 v23, 0
    v_mov_b32 v190, 0
    v_mov_b32 v38, 0
    v_mov_b32 v191, 0
    v_mov_b32 v39, 0
    v_mov_b32 v206, 0
    v_mov_b32 v54, 0
    v_mov_b32 v207, 0
    v_mov_b32 v55, 0
    v_mov_b32 v222, 0
    v_mov_b32 v70, 0
    v_mov_b32 v223, 0
    v_mov_b32 v71, 0
    s_waitcnt lgkmcnt(0)
    ds_read_b64_tr_b16 v[8:9], v7 offset:8192
    ds_read_b64_tr_b16 v[10:11], v7 offset:8704
    ds_read_b64_tr_b16 v[12:13], v7 offset:12288
    ds_read_b64_tr_b16 v[14:15], v7 offset:12800
    ds_read_b64_tr_b16 v[16:17], v7 offset:16384
    ds_read_b64_tr_b16 v[18:19], v7 offset:16896
    ds_read_b64_tr_b16 v[20:21], v132 offset:20480
    v_and_b32 v160, v144, v136
    v_and_b32 v161, v145, v136
    v_and_b32 v162, v146, v136
    v_and_b32 v163, v147, v136
    v_and_b32 v164, v148, v136
    v_and_b32 v165, v149, v136
    v_and_b32 v166, v150, v136
    v_and_b32 v167, v151, v136
    v_and_b32 v168, v152, v136
    v_and_b32 v169, v153, v136
    v_and_b32 v170, v154, v136
    v_and_b32 v171, v155, v136
    v_and_b32 v172, v156, v136
    v_and_b32 v173, v157, v136
    ds_read_b64_tr_b16 v[24:25], v7 offset:8224
    ds_read_b64_tr_b16 v[26:27], v7 offset:8736
    ds_read_b64_tr_b16 v[28:29], v7 offset:12320
    ds_read_b64_tr_b16 v[30:31], v7 offset:12832
    ds_read_b64_tr_b16 v[32:33], v7 offset:16416
    ds_read_b64_tr_b16 v[34:35], v7 offset:16928
    ds_read_b64_tr_b16 v[36:37], v132 offset:20512
    v_and_b32 v176, v144, v137
    v_and_b32 v177, v145, v137
    v_and_b32 v178, v146, v137
    v_and_b32 v179, v147, v137
    v_and_b32 v180, v148, v137
    v_and_b32 v181, v149, v137
    v_and_b32 v182, v150, v137
    v_and_b32 v183, v151, v137
    v_and_b32 v184, v152, v137
    v_and_b32 v185, v153, v137
    v_and_b32 v186, v154, v137
    v_and_b32 v187, v155, v137
    v_and_b32 v188, v156, v137
    v_and_b32 v189, v157, v137
    ds_read_b64_tr_b16 v[40:41], v7 offset:8256
    ds_read_b64_tr_b16 v[42:43], v7 offset:8768
    ds_read_b64_tr_b16 v[44:45], v7 offset:12352
    ds_read_b64_tr_b16 v[46:47], v7 offset:12864
    ds_read_b64_tr_b16 v[48:49], v7 offset:16448
    ds_read_b64_tr_b16 v[50:51], v7 offset:16960
    ds_read_b64_tr_b16 v[52:53], v132 offset:20544
    v_and_b32 v192, v144, v138
    v_and_b32 v193, v145, v138
    v_and_b32 v194, v146, v138
    v_and_b32 v195, v147, v138
    v_and_b32 v196, v148, v138
    v_and_b32 v197, v149, v138
    v_and_b32 v198, v150, v138
    v_and_b32 v199, v151, v138
    v_and_b32 v200, v152, v138
    v_and_b32 v201, v153, v138
    v_and_b32 v202, v154, v138
    v_and_b32 v203, v155, v138
    v_and_b32 v204, v156, v138
    v_and_b32 v205, v157, v138
    ds_read_b64_tr_b16 v[56:57], v7 offset:8288
    ds_read_b64_tr_b16 v[58:59], v7 offset:8800
    ds_read_b64_tr_b16 v[60:61], v7 offset:12384
    ds_read_b64_tr_b16 v[62:63], v7 offset:12896
    ds_read_b64_tr_b16 v[64:65], v7 offset:16480
    ds_read_b64_tr_b16 v[66:67], v7 offset:16992
    ds_read_b64_tr_b16 v[68:69], v132 offset:20576
    v_and_b32 v208, v144, v139
    v_and_b32 v209, v145, v139
    v_and_b32 v210, v146, v139
    v_and_b32 v211, v147, v139
    v_and_b32 v212, v148, v139
    v_and_b32 v213, v149, v139
    v_and_b32 v214, v150, v139
    v_and_b32 v215, v151, v139
    v_and_b32 v216, v152, v139
    v_and_b32 v217, v153, v139
    v_and_b32 v218, v154, v139
    v_and_b32 v219, v155, v139
    v_and_b32 v220, v156, v139
    v_and_b32 v221, v157, v139
    s_waitcnt lgkmcnt(0)
    v_mfma_f32_16x16x32_bf16 v[120:123], v[8:11], v[160:163], 0
    v_mfma_f32_16x16x32_bf16 v[120:123], v[12:15], v[164:167], v[120:123]
    v_mfma_f32_16x16x32_bf16 v[120:123], v[16:19], v[168:171], v[120:123]
    v_mfma_f32_16x16x32_bf16 v[120:123], v[20:23], v[172:175], v[120:123]
    v_mfma_f32_16x16x32_bf16 v[120:123], v[24:27], v[176:179], v[120:123]
    v_mfma_f32_16x16x32_bf16 v[120:123], v[28:31], v[180:183], v[120:123]
    v_mfma_f32_16x16x32_bf16 v[120:123], v[32:35], v[184:187], v[120:123]
    v_mfma_f32_16x16x32_bf16 v[120:123], v[36:39], v[188:191], v[120:123]
    v_mfma_f32_16x16x32_bf16 v[120:123], v[40:43], v[192:195], v[120:123]
    v_mfma_f32_16x16x32_bf16 v[120:123], v[44:47], v[196:199], v[120:123]
    v_mfma_f32_16x16x32_bf16 v[120:123], v[48:51], v[200:203], v[120:123]
    v_mfma_f32_16x16x32_bf16 v[120:123], v[52:55], v[204:207], v[120:123]
    v_mfma_f32_16x16x32_bf16 v[120:123], v[56:59], v[208:211], v[120:123]
    v_mfma_f32_16x16x32_bf16 v[120:123], v[60:63], v[212:215], v[120:123]
    v_mfma_f32_16x16x32_bf16 v[120:123], v[64:67], v[216:219], v[120:123]
    v_mfma_f32_16x16x32_bf16 v[120:123], v[68:71], v[220:223], v[120:123]
    s_nop 7
    v_bfi_b32 v120, v141, s72, v120
    v_bfi_b32 v121, v140, s69, v121
    v_bfi_b32 v122, v140, s70, v122
    v_bfi_b32 v123, v140, s71, v123
    s_waitcnt vmcnt(0)
    s_mov_b32 exec_lo, 0x00ff00ff
    s_mov_b32 exec_hi, 0x00ff00ff
    buffer_store_dwordx4 v[120:123], v126, s[56:59], 0 offen
    s_mov_b64 exec, -1
    v_lshlrev_b32 v4, 4, v5
    s_waitcnt vmcnt(1)
    ds_read_b128 v[8:11], v4 offset:4096
    ds_read_b128 v[12:15], v4 offset:4160
    ds_read_b128 v[16:19], v4 offset:4224
    ds_read_b128 v[20:23], v4 offset:4288
    ds_read_b128 v[24:27], v4 offset:4352
    ds_read_b128 v[28:31], v4 offset:4416
    ds_read_b128 v[32:35], v4 offset:4480
    ds_read_b128 v[36:39], v4 offset:4544
    ds_read_b128 v[40:43], v4 offset:4608
    ds_read_b128 v[44:47], v4 offset:4672
    ds_read_b128 v[48:51], v4 offset:4736
    ds_read_b128 v[52:55], v4 offset:4800
    ds_read_b128 v[56:59], v4 offset:4864
    ds_read_b128 v[60:63], v4 offset:4928
    ds_read_b128 v[64:67], v6 offset:0
    ds_read_b128 v[68:71], v6 offset:64
    ds_read_b128 v[72:75], v6 offset:128
    ds_read_b128 v[76:79], v6 offset:192
    ds_read_b128 v[80:83], v6 offset:256
    ds_read_b128 v[84:87], v6 offset:320
    ds_read_b128 v[88:91], v6 offset:384
    ds_read_b128 v[92:95], v6 offset:448
    ds_read_b128 v[96:99], v6 offset:512
    ds_read_b128 v[100:103], v6 offset:576
    ds_read_b128 v[104:107], v6 offset:640
    ds_read_b128 v[108:111], v6 offset:704
    ds_read_b128 v[112:115], v6 offset:768
    ds_read_b128 v[116:119], v6 offset:832
    s_waitcnt lgkmcnt(0)
    v_mfma_f32_16x16x32_bf16 v[144:147], v[8:11], v[64:67], 0
    v_mfma_f32_16x16x32_bf16 v[144:147], v[12:15], v[68:71], v[144:147]
    v_mfma_f32_16x16x32_bf16 v[144:147], v[16:19], v[72:75], v[144:147]
    v_mfma_f32_16x16x32_bf16 v[144:147], v[20:23], v[76:79], v[144:147]
    v_mfma_f32_16x16x32_bf16 v[144:147], v[24:27], v[80:83], v[144:147]
    v_mfma_f32_16x16x32_bf16 v[144:147], v[28:31], v[84:87], v[144:147]
    v_mfma_f32_16x16x32_bf16 v[144:147], v[32:35], v[88:91], v[144:147]
    v_mfma_f32_16x16x32_bf16 v[144:147], v[36:39], v[92:95], v[144:147]
    v_mfma_f32_16x16x32_bf16 v[144:147], v[40:43], v[96:99], v[144:147]
    v_mfma_f32_16x16x32_bf16 v[144:147], v[44:47], v[100:103], v[144:147]
    v_mfma_f32_16x16x32_bf16 v[144:147], v[48:51], v[104:107], v[144:147]
    v_mfma_f32_16x16x32_bf16 v[144:147], v[52:55], v[108:111], v[144:147]
    v_mfma_f32_16x16x32_bf16 v[144:147], v[56:59], v[112:115], v[144:147]
    v_mfma_f32_16x16x32_bf16 v[144:147], v[60:63], v[116:119], v[144:147]
    s_nop 7
    v_mul_f32 v128, 0xbfb8aa3b, v144
    v_exp_f32 v128, v128
    s_nop 0
    v_add_f32 v128, 1.0, v128
    v_rcp_f32 v128, v128
    s_nop 0
    v_sub_f32 v129, 1.0, v128
    v_readlane_b32 s73, v128, s8
    s_mov_b32 s12, 4096
    s_waitcnt vmcnt(0)
    s_mov_b32 s11, 400003
L_poll_q:
    s_sleep 16
    s_cmp_le_u32 s11, 399999
    s_cbranch_scc1 L_q_dev
    buffer_load_dwordx4 v[8:11], v127, s[56:59], 0 offen offset:0 nt
    buffer_load_dwordx4 v[12:15], v127, s[56:59], 0 offen offset:1024 nt
    buffer_load_dwordx4 v[16:19], v127, s[56:59], 0 offen offset:2048 nt
    buffer_load_dwordx4 v[20:23], v127, s[56:59], 0 offen offset:3072 nt
    buffer_load_dwordx4 v[24:27], v127, s[56:59], s12 offen offset:0 nt
    buffer_load_dwordx4 v[28:31], v127, s[56:59], s12 offen offset:1024 nt
    buffer_load_dwordx4 v[32:35], v127, s[56:59], s12 offen offset:2048 nt
    buffer_load_dwordx4 v[36:39], v127, s[56:59], s12 offen offset:3072 nt
    s_branch L_q_issued
L_q_dev:
    s_cmp_lg_u32 s11, 399999
    s_cbranch_scc1 L_q_dev2
    s_mov_b32 exec_lo, 0x00ff00ff
    s_mov_b32 exec_hi, 0x00ff00ff
    buffer_store_dwordx4 v[120:123], v126, s[56:59], 0 offen sc1
    s_mov_b64 exec, -1
L_q_dev2:
    buffer_load_dwordx4 v[8:11], v127, s[56:59], 0 offen offset:0 sc1
    buffer_load_dwordx4 v[12:15], v127, s[56:59], 0 offen offset:1024 sc1
    buffer_load_dwordx4 v[16:19], v127, s[56:59], 0 offen offset:2048 sc1
    buffer_load_dwordx4 v[20:23], v127, s[56:59], 0 offen offset:3072 sc1
    buffer_load_dwordx4 v[24:27], v127, s[56:59], s12 offen offset:0 sc1
    buffer_load_dwordx4 v[28:31], v127, s[56:59], s12 offen offset:1024 sc1
    buffer_load_dwordx4 v[32:35], v127, s[56:59], s12 offen offset:2048 sc1
    buffer_load_dwordx4 v[36:39], v127, s[56:59], s12 offen offset:3072 sc1
L_q_issued:
    s_sub_u32 s11, s11, 1
    s_cbranch_scc1 L_q_ok
    s_waitcnt vmcnt(0)
    v_perm_b32 v133, v9, v8, s42
    v_perm_b32 v134, v11, v10, s45
    v_or_b32 v133, v133, v134
    v_xor_b32 v135, s46, v133
    v_perm_b32 v133, v13, v12, s42
    v_perm_b32 v134, v15, v14, s45
    v_or_b32 v133, v133, v134
    v_xor_b32 v133, s46, v133
    v_or_b32 v135, v135, v133
    v_perm_b32 v133, v17, v16, s42
    v_perm_b32 v134, v19, v18, s45
    v_or_b32 v133, v133, v134
    v_xor_b32 v133, s46, v133
    v_or_b32 v135, v135, v133
    v_perm_b32 v133, v21, v20, s42
    v_perm_b32 v134, v23, v22, s45
    v_or_b32 v133, v133, v134
    v_xor_b32 v133, s46, v133
    v_or_b32 v135, v135, v133
    v_perm_b32 v133, v25, v24, s42
    v_perm_b32 v134, v27, v26, s45
    v_or_b32 v133, v133, v134
    v_xor_b32 v133, s46, v133
    v_or_b32 v135, v135, v133
    v_perm_b32 v133, v29, v28, s42
    v_perm_b32 v134, v31, v30, s45
    v_or_b32 v133, v133, v134
    v_xor_b32 v133, s46, v133
    v_or_b32 v135, v135, v133
    v_perm_b32 v133, v33, v32, s42
    v_perm_b32 v134, v35, v34, s45
    v_or_b32 v133, v133, v134
    v_xor_b32 v133, s46, v133
    v_or_b32 v135, v135, v133
    v_perm_b32 v133, v37, v36, s42
    v_perm_b32 v134, v39, v38, s45
    v_or_b32 v133, v133, v134
    v_xor_b32 v133, s46, v133
    v_or_b32 v135, v135, v133
    v_cmp_ne_u32 vcc, 0, v135
    s_cbranch_vccnz L_poll_q
L_q_ok:
    s_waitcnt vmcnt(0)
    v_xor_b32 v135, s72, v8
    v_xor_b32 v133, s72, v12
    v_or_b32 v135, v135, v133
    v_xor_b32 v133, s72, v16
    v_or_b32 v135, v135, v133
    v_xor_b32 v133, s72, v20
    v_or_b32 v135, v135, v133
    v_xor_b32 v133, s72, v24
    v_or_b32 v135, v135, v133
    v_xor_b32 v133, s72, v28
    v_or_b32 v135, v135, v133
    v_xor_b32 v133, s72, v32
    v_or_b32 v135, v135, v133
    v_xor_b32 v133, s72, v36
    v_or_b32 v135, v135, v133
    v_and_b32 v135, 0x700, v135
    v_cmp_ne_u32 vcc, 0, v135
    s_movk_i32 s78, 0x80
    s_movk_i32 s79, 0x400
    v_bfi_b32 v8, v141, s79, v8
    v_bfi_b32 v9, v140, s78, v9
    v_bfi_b32 v10, v140, s78, v10
    v_bfi_b32 v11, v140, s78, v11
    v_bfi_b32 v12, v141, s79, v12
    v_bfi_b32 v13, v140, s78, v13
    v_bfi_b32 v14, v140, s78, v14
    v_bfi_b32 v15, v140, s78, v15
    v_bfi_b32 v16, v141, s79, v16
    v_bfi_b32 v17, v140, s78, v17
    v_bfi_b32 v18, v140, s78, v18
    v_bfi_b32 v19, v140, s78, v19
    v_bfi_b32 v20, v141, s79, v20
    v_bfi_b32 v21, v140, s78, v21
    v_bfi_b32 v22, v140, s78, v22
    v_bfi_b32 v23, v140, s78, v23
    v_bfi_b32 v24, v141, s79, v24
    v_bfi_b32 v25, v140, s78, v25
    v_bfi_b32 v26, v140, s78, v26
    v_bfi_b32 v27, v140, s78, v27
    v_bfi_b32 v28, v141, s79, v28
    v_bfi_b32 v29, v140, s78, v29
    v_bfi_b32 v30, v140, s78, v30
    v_bfi_b32 v31, v140, s78, v31
    v_bfi_b32 v32, v141, s79, v32
    v_bfi_b32 v33, v140, s78, v33
    v_bfi_b32 v34, v140, s78, v34
    v_bfi_b32 v35, v140, s78, v35
    v_bfi_b32 v36, v141, s79, v36
    v_bfi_b32 v37, v140, s78, v37
    v_bfi_b32 v38, v140, s78, v38
    v_bfi_b32 v39, v140, s78, v39
    v_add_f32 v8, v8, v16
    v_add_f32 v24, v24, v32
    v_add_f32 v9, v9, v17
    v_add_f32 v25, v25, v33
    v_add_f32 v10, v10, v18
    v_add_f32 v26, v26, v34
    v_add_f32 v11, v11, v19
    v_add_f32 v27, v27, v35
    v_add_f32 v12, v12, v20
    v_add_f32 v28, v28, v36
    v_add_f32 v13, v13, v21
    v_add_f32 v29, v29, v37
    v_add_f32 v14, v14, v22
    v_add_f32 v30, v30, v38
    v_add_f32 v15, v15, v23
    v_add_f32 v31, v31, v39
    s_cmp_lg_u64 vcc, 0
    s_cselect_b32 s15, 1, 0
    s_cbranch_scc0 L_q_same
    s_mov_b32 exec_lo, 0x00ff00ff
    s_mov_b32 exec_hi, 0x00ff00ff
    buffer_store_dwordx4 v[120:123], v126, s[56:59], 0 offen sc1
    s_mov_b64 exec, -1
L_q_same:
    v_add_f32 v8, v8, v24
    v_add_f32 v9, v9, v25
    v_add_f32 v10, v10, v26
    v_add_f32 v11, v11, v27
    v_add_f32 v12, v12, v28
    v_add_f32 v13, v13, v29
    v_add_f32 v14, v14, v30
    v_add_f32 v15, v15, v31
    v_cvt_pk_bf16_f32 v40, v8, v9
    v_cvt_pk_bf16_f32 v41, v10, v11
    v_cvt_pk_bf16_f32 v42, v12, v13
    v_cvt_pk_bf16_f32 v43, v14, v15
    v_lshlrev_b32 v4, 3, v1
    v_mov_b32 v44, s15
    v_mov_b32 v45, s46
    v_mov_b32 v46, 1
    v_mov_b32 v47, 0
    ds_write_b64 v4, v[40:41] offset:2048
    ds_write_b64 v4, v[42:43] offset:2560
    s_waitcnt lgkmcnt(0)
    ds_write_b96 v47, v[44:46] offset:3264
    v_mov_b32 v120, -1
    v_mov_b32 v121, -1
    v_mov_b32 v122, -1
    v_mov_b32 v123, -1
    v_mov_b32 v126, v2
    s_lshl_b32 s11, s6, 1
    s_add_u32 s11, s11, s8
    s_lshl_b32 s11, s11, 14
    s_lshl_b32 s12, s5, 10
    s_add_u32 s11, s11, s12
    s_add_u32 s11, s11, 524288
    s_cmp_lg_u32 s15, 0
    s_cbranch_scc1 L_ms2
    buffer_store_dwordx4 v[120:123], v126, s[56:59], s11 offen
    s_branch L_mx2
L_ms2:
    buffer_store_dwordx4 v[120:123], v126, s[56:59], s11 offen sc1
L_mx2:
    s_cmp_lg_u32 s2, 254
    s_cbranch_scc1 L_glu
    v_mov_b32 v116, 0
    v_mov_b32 v117, 0
    v_mov_b32 v118, 0
    v_mov_b32 v119, 0
    v_lshrrev_b32 v4, 2, v1
    v_lshlrev_b32 v124, 8, v4
    v_and_b32 v4, 3, v1
    v_lshl_add_u32 v124, v4, 4, v124
    s_mov_b32 s11, 32768
    buffer_store_dwordx4 v[116:119], v124, s[56:59], s11 offen sc1
    buffer_store_dwordx4 v[116:119], v124, s[56:59], s11 offen offset:64 sc1
    s_mov_b32 s11, 36864
    buffer_store_dwordx4 v[116:119], v124, s[56:59], s11 offen sc1
    buffer_store_dwordx4 v[116:119], v124, s[56:59], s11 offen offset:64 sc1
    s_mov_b32 s11, 40960
    buffer_store_dwordx4 v[116:119], v124, s[56:59], s11 offen sc1
    buffer_store_dwordx4 v[116:119], v124, s[56:59], s11 offen offset:64 sc1
    s_mov_b32 s11, 45056
    buffer_store_dwordx4 v[116:119], v124, s[56:59], s11 offen sc1
    buffer_store_dwordx4 v[116:119], v124, s[56:59], s11 offen offset:64 sc1
    s_mov_b32 s11, 49152
    buffer_store_dwordx4 v[116:119], v124, s[56:59], s11 offen sc1
    buffer_store_dwordx4 v[116:119], v124, s[56:59], s11 offen offset:64 sc1
    s_mov_b32 s11, 53248
    buffer_store_dwordx4 v[116:119], v124, s[56:59], s11 offen sc1
    buffer_store_dwordx4 v[116:119], v124, s[56:59], s11 offen offset:64 sc1
    s_mov_b32 s11, 57344
    buffer_store_dwordx4 v[116:119], v124, s[56:59], s11 offen sc1
    buffer_store_dwordx4 v[116:119], v124, s[56:59], s11 offen offset:64 sc1
    v_mul_u32_u24 v125, 4352, v1
    s_mov_b32 s11, 786432
    s_mov_b32 exec_lo, 0xffff
    s_mov_b32 exec_hi, 0
    buffer_store_dword v116, v125, s[56:59], s11 offen sc1
    s_mov_b64 exec, -1
    s_waitcnt vmcnt(0)
    v_bfi_b32 v116, v140, s68, v116
    v_bfi_b32 v117, v140, s69, v117
    v_bfi_b32 v118, v140, s70, v118
    v_bfi_b32 v119, v140, s71, v119
    v_mov_b32 v125, 1024
    s_mov_b64 exec, 1
    buffer_store_dwordx4 v[116:119], v125, s[56:59], 0 offen sc1
    buffer_store_dword v45, v125, s[56:59], 0 offen offset:512 sc1
    s_mov_b64 exec, -1
L_glu:
    s_and_b32 s74, s6, 1
    s_lshr_b32 s13, s6, 1
    s_mul_i32 s13, s13, 7
    s_mul_i32 s14, s74, 3
    s_add_u32 s13, s13, s14
    s_add_u32 s74, s74, 3
    s_lshr_b32 s14, s7, 3
    s_cmp_ge_u32 s14, s74
    s_cbranch_scc1 L_glu_done
    v_bfe_u32 v4, v1, 1, 2
    v_lshlrev_b32 v126, 6, v4
    v_lshl_add_u32 v126, v5, 4, v126
    v_and_b32 v4, 1, v1
    v_lshl_add_u32 v126, v4, 8, v126
    s_lshl_b32 s11, s6, 5
    s_add_u32 s11, s11, s7
    s_lshl_b32 s11, s11, 9
    s_add_u32 s75, s11, 131072
    s_mov_b32 s11, 3200024
L_gf_wait:
    ds_read_b128 v[8:11], v47 offset:3296
    s_sub_u32 s11, s11, 1
    s_cbranch_scc1 L_gf_ok
    s_waitcnt lgkmcnt(0)
    v_min3_u32 v4, v8, v9, v10
    v_min_u32 v4, v4, v11
    v_cmp_gt_u32 vcc, 2, v4
    s_cbranch_vccnz L_gf_wait
L_gf_ok:
    s_waitcnt vmcnt(0) lgkmcnt(0)
    ds_read_b64_tr_b16 v[8:9], v7 offset:24576
    ds_read_b64_tr_b16 v[10:11], v7 offset:25088
    ds_read_b64_tr_b16 v[12:13], v7 offset:28672
    ds_read_b64_tr_b16 v[14:15], v7 offset:29184
    ds_read_b64_tr_b16 v[16:17], v7 offset:32768
    ds_read_b64_tr_b16 v[18:19], v7 offset:33280
    ds_read_b64_tr_b16 v[20:21], v132 offset:36864
    v_mov_b32 v22, 0
    v_mov_b32 v23, 0
    ds_read_b64_tr_b16 v[24:25], v7 offset:24608
    ds_read_b64_tr_b16 v[26:27], v7 offset:25120
    ds_read_b64_tr_b16 v[28:29], v7 offset:28704
    ds_read_b64_tr_b16 v[30:31], v7 offset:29216
    ds_read_b64_tr_b16 v[32:33], v7 offset:32800
    ds_read_b64_tr_b16 v[34:35], v7 offset:33312
    ds_read_b64_tr_b16 v[36:37], v132 offset:36896
    v_mov_b32 v38, 0
    v_mov_b32 v39, 0
    ds_read_b64_tr_b16 v[40:41], v7 offset:24640
    ds_read_b64_tr_b16 v[42:43], v7 offset:25152
    ds_read_b64_tr_b16 v[44:45], v7 offset:28736
    ds_read_b64_tr_b16 v[46:47], v7 offset:29248
    ds_read_b64_tr_b16 v[48:49], v7 offset:32832
    ds_read_b64_tr_b16 v[50:51], v7 offset:33344
    ds_read_b64_tr_b16 v[52:53], v132 offset:36928
    v_mov_b32 v54, 0
    v_mov_b32 v55, 0
    ds_read_b64_tr_b16 v[56:57], v7 offset:24672
    ds_read_b64_tr_b16 v[58:59], v7 offset:25184
    ds_read_b64_tr_b16 v[60:61], v7 offset:28768
    ds_read_b64_tr_b16 v[62:63], v7 offset:29280
    ds_read_b64_tr_b16 v[64:65], v7 offset:32864
    ds_read_b64_tr_b16 v[66:67], v7 offset:33376
    ds_read_b64_tr_b16 v[68:69], v132 offset:36960
    v_mov_b32 v70, 0
    v_mov_b32 v71, 0
    s_waitcnt lgkmcnt(0)
    v_mfma_f32_16x16x32_bf16 v[120:123], v[8:11], v[160:163], 0
    v_mfma_f32_16x16x32_bf16 v[120:123], v[12:15], v[164:167], v[120:123]
    v_mfma_f32_16x16x32_bf16 v[120:123], v[16:19], v[168:171], v[120:123]
    v_mfma_f32_16x16x32_bf16 v[120:123], v[20:23], v[172:175], v[120:123]
    v_mfma_f32_16x16x32_bf16 v[120:123], v[24:27], v[176:179], v[120:123]
    v_mfma_f32_16x16x32_bf16 v[120:123], v[28:31], v[180:183], v[120:123]
    v_mfma_f32_16x16x32_bf16 v[120:123], v[32:35], v[184:187], v[120:123]
    v_mfma_f32_16x16x32_bf16 v[120:123], v[36:39], v[188:191], v[120:123]
    v_mfma_f32_16x16x32_bf16 v[120:123], v[40:43], v[192:195], v[120:123]
    v_mfma_f32_16x16x32_bf16 v[120:123], v[44:47], v[196:199], v[120:123]
    v_mfma_f32_16x16x32_bf16 v[120:123], v[48:51], v[200:203], v[120:123]
    v_mfma_f32_16x16x32_bf16 v[120:123], v[52:55], v[204:207], v[120:123]
    v_mfma_f32_16x16x32_bf16 v[120:123], v[56:59], v[208:211], v[120:123]
    v_mfma_f32_16x16x32_bf16 v[120:123], v[60:63], v[212:215], v[120:123]
    v_mfma_f32_16x16x32_bf16 v[120:123], v[64:67], v[216:219], v[120:123]
    v_mfma_f32_16x16x32_bf16 v[120:123], v[68:71], v[220:223], v[120:123]
    s_nop 7
    v_bfi_b32 v120, v140, s68, v120
    v_bfi_b32 v121, v140, s69, v121
    v_bfi_b32 v122, v140, s70, v122
    v_bfi_b32 v123, v140, s71, v123
    s_mov_b32 exec_lo, 0x00ff00ff
    s_mov_b32 exec_hi, 0x00ff00ff
    s_cmp_lg_u32 s15, 0
    s_cbranch_scc1 L_ms3
    buffer_store_dwordx4 v[120:123], v126, s[56:59], s75 offen
    s_branch L_mx3
L_ms3:
    buffer_store_dwordx4 v[120:123], v126, s[56:59], s75 offen sc1
L_mx3:
    s_mov_b64 exec, -1
    s_cmp_ge_u32 s9, s74
    s_cbranch_scc1 L_glu_done
    v_and_b32 v4, 1, v1
    v_lshlrev_b32 v127, 8, v4
    v_bfe_u32 v4, v1, 1, 1
    v_lshl_add_u32 v127, v4, 7, v127
    v_bfe_u32 v4, v1, 2, 2
    v_lshl_add_u32 v127, v4, 9, v127
    v_lshl_add_u32 v127, v5, 5, v127
    s_lshl_b32 s11, s6, 2
    s_add_u32 s11, s11, s9
    s_lshl_b32 s11, s11, 12
    s_add_u32 s11, s11, 131072
    v_add_u32 v127, s11, v127
    v_or_b32 v142, v136, v138
    v_or_b32 v143, v137, v139
    s_mov_b32 s11, 400003
L_poll_h:
    s_sleep 24
    s_bfe_u32 s76, s11, 0x10002
    s_or_b32 s76, s76, s15
    s_cbranch_scc1 L_ml4
    buffer_load_dwordx4 v[8:11], v127, s[56:59], 0 offen offset:0 nt
    buffer_load_dwordx4 v[12:15], v127, s[56:59], 0 offen offset:16 nt
    buffer_load_dwordx4 v[16:19], v127, s[56:59], 0 offen offset:2048 nt
    buffer_load_dwordx4 v[20:23], v127, s[56:59], 0 offen offset:2064 nt
    s_branch L_mlx4
L_ml4:
    buffer_load_dwordx4 v[8:11], v127, s[56:59], 0 offen offset:0 sc1
    buffer_load_dwordx4 v[12:15], v127, s[56:59], 0 offen offset:16 sc1
    buffer_load_dwordx4 v[16:19], v127, s[56:59], 0 offen offset:2048 sc1
    buffer_load_dwordx4 v[20:23], v127, s[56:59], 0 offen offset:2064 sc1
L_mlx4:
    s_sub_u32 s11, s11, 1
    s_cbranch_scc1 L_h_ok
    s_waitcnt vmcnt(0)
    v_perm_b32 v133, v9, v8, s42
    v_perm_b32 v134, v11, v10, s45
    v_or_b32 v133, v133, v134
    v_xor_b32 v135, s46, v133
    v_perm_b32 v133, v13, v12, s42
    v_perm_b32 v134, v15, v14, s45
    v_or_b32 v133, v133, v134
    v_xor_b32 v133, s46, v133
    v_or_b32 v135, v135, v133
    v_perm_b32 v133, v17, v16, s42
    v_perm_b32 v134, v19, v18, s45
    v_or_b32 v133, v133, v134
    v_xor_b32 v133, s46, v133
    v_or_b32 v135, v135, v133
    v_perm_b32 v133, v21, v20, s42
    v_perm_b32 v134, v23, v22, s45
    v_or_b32 v133, v133, v134
    v_xor_b32 v133, s46, v133
    v_or_b32 v135, v135, v133
    v_cmp_ne_u32 vcc, 0, v135
    s_cbranch_vccnz L_poll_h
L_h_ok:
    s_waitcnt vmcnt(0)
    ds_read_b64_tr_b16 v[64:65], v7 offset:40960
    ds_read_b64_tr_b16 v[66:67], v7 offset:41472
    ds_read_b64_tr_b16 v[68:69], v7 offset:40992
    ds_read_b64_tr_b16 v[70:71], v7 offset:41504
    ds_read_b64_tr_b16 v[72:73], v7 offset:41024
    ds_read_b64_tr_b16 v[74:75], v7 offset:41536
    ds_read_b64_tr_b16 v[76:77], v7 offset:41056
    ds_read_b64_tr_b16 v[78:79], v7 offset:41568
    ds_read_b64_tr_b16 v[80:81], v7 offset:45056
    ds_read_b64_tr_b16 v[82:83], v7 offset:45568
    ds_read_b64_tr_b16 v[84:85], v7 offset:45088
    ds_read_b64_tr_b16 v[86:87], v7 offset:45600
    ds_read_b64_tr_b16 v[88:89], v7 offset:45120
    ds_read_b64_tr_b16 v[90:91], v7 offset:45632
    ds_read_b64_tr_b16 v[92:93], v7 offset:45152
    ds_read_b64_tr_b16 v[94:95], v7 offset:45664
    v_bfi_b32 v8, v140, s78, v8
    v_bfi_b32 v9, v140, s78, v9
    v_bfi_b32 v10, v140, s78, v10
    v_bfi_b32 v11, v140, s78, v11
    v_bfi_b32 v12, v140, s78, v12
    v_bfi_b32 v13, v140, s78, v13
    v_bfi_b32 v14, v140, s78, v14
    v_bfi_b32 v15, v140, s78, v15
    v_bfi_b32 v16, v140, s78, v16
    v_bfi_b32 v17, v140, s78, v17
    v_bfi_b32 v18, v140, s78, v18
    v_bfi_b32 v19, v140, s78, v19
    v_bfi_b32 v20, v140, s78, v20
    v_bfi_b32 v21, v140, s78, v21
    v_bfi_b32 v22, v140, s78, v22
    v_bfi_b32 v23, v140, s78, v23
    v_add_f32_dpp v8, v8, v8 row_ror:8 row_mask:0xf bank_mask:0xf
    v_add_f32_dpp v9, v9, v9 row_ror:8 row_mask:0xf bank_mask:0xf
    v_add_f32_dpp v10, v10, v10 row_ror:8 row_mask:0xf bank_mask:0xf
    v_add_f32_dpp v11, v11, v11 row_ror:8 row_mask:0xf bank_mask:0xf
    v_add_f32_dpp v12, v12, v12 row_ror:8 row_mask:0xf bank_mask:0xf
    v_add_f32_dpp v13, v13, v13 row_ror:8 row_mask:0xf bank_mask:0xf
    v_add_f32_dpp v14, v14, v14 row_ror:8 row_mask:0xf bank_mask:0xf
    v_add_f32_dpp v15, v15, v15 row_ror:8 row_mask:0xf bank_mask:0xf
    v_add_f32_dpp v16, v16, v16 row_ror:8 row_mask:0xf bank_mask:0xf
    v_add_f32_dpp v17, v17, v17 row_ror:8 row_mask:0xf bank_mask:0xf
    v_add_f32_dpp v18, v18, v18 row_ror:8 row_mask:0xf bank_mask:0xf
    v_add_f32_dpp v19, v19, v19 row_ror:8 row_mask:0xf bank_mask:0xf
    v_add_f32_dpp v20, v20, v20 row_ror:8 row_mask:0xf bank_mask:0xf
    v_add_f32_dpp v21, v21, v21 row_ror:8 row_mask:0xf bank_mask:0xf
    v_add_f32_dpp v22, v22, v22 row_ror:8 row_mask:0xf bank_mask:0xf
    v_add_f32_dpp v23, v23, v23 row_ror:8 row_mask:0xf bank_mask:0xf
    v_add_f32_dpp v8, v8, v8 row_ror:4 row_mask:0xf bank_mask:0xf
    v_add_f32_dpp v9, v9, v9 row_ror:4 row_mask:0xf bank_mask:0xf
    v_add_f32_dpp v10, v10, v10 row_ror:4 row_mask:0xf bank_mask:0xf
    v_add_f32_dpp v11, v11, v11 row_ror:4 row_mask:0xf bank_mask:0xf
    v_add_f32_dpp v12, v12, v12 row_ror:4 row_mask:0xf bank_mask:0xf
    v_add_f32_dpp v13, v13, v13 row_ror:4 row_mask:0xf bank_mask:0xf
    v_add_f32_dpp v14, v14, v14 row_ror:4 row_mask:0xf bank_mask:0xf
    v_add_f32_dpp v15, v15, v15 row_ror:4 row_mask:0xf bank_mask:0xf
    v_add_f32_dpp v16, v16, v16 row_ror:4 row_mask:0xf bank_mask:0xf
    v_add_f32_dpp v17, v17, v17 row_ror:4 row_mask:0xf bank_mask:0xf
    v_add_f32_dpp v18, v18, v18 row_ror:4 row_mask:0xf bank_mask:0xf
    v_add_f32_dpp v19, v19, v19 row_ror:4 row_mask:0xf bank_mask:0xf
    v_add_f32_dpp v20, v20, v20 row_ror:4 row_mask:0xf bank_mask:0xf
    v_add_f32_dpp v21, v21, v21 row_ror:4 row_mask:0xf bank_mask:0xf
    v_add_f32_dpp v22, v22, v22 row_ror:4 row_mask:0xf bank_mask:0xf
    v_add_f32_dpp v23, v23, v23 row_ror:4 row_mask:0xf bank_mask:0xf
    v_mul_f32 v8, 0xbfb8aa3b, v8
    v_exp_f32 v8, v8
    s_nop 0
    v_add_f32 v8, 1.0, v8
    v_rcp_f32 v8, v8
    s_nop 0
    v_mul_f32 v8, v8, v16
    v_mul_f32 v9, 0xbfb8aa3b, v9
    v_exp_f32 v9, v9
    s_nop 0
    v_add_f32 v9, 1.0, v9
    v_rcp_f32 v9, v9
    s_nop 0
    v_mul_f32 v9, v9, v17
    v_mul_f32 v10, 0xbfb8aa3b, v10
    v_exp_f32 v10, v10
    s_nop 0
    v_add_f32 v10, 1.0, v10
    v_rcp_f32 v10, v10
    s_nop 0
    v_mul_f32 v10, v10, v18
    v_mul_f32 v11, 0xbfb8aa3b, v11
    v_exp_f32 v11, v11
    s_nop 0
    v_add_f32 v11, 1.0, v11
    v_rcp_f32 v11, v11
    s_nop 0
    v_mul_f32 v11, v11, v19
    v_mul_f32 v12, 0xbfb8aa3b, v12
    v_exp_f32 v12, v12
    s_nop 0
    v_add_f32 v12, 1.0, v12
    v_rcp_f32 v12, v12
    s_nop 0
    v_mul_f32 v12, v12, v20
    v_mul_f32 v13, 0xbfb8aa3b, v13
    v_exp_f32 v13, v13
    s_nop 0
    v_add_f32 v13, 1.0, v13
    v_rcp_f32 v13, v13
    s_nop 0
    v_mul_f32 v13, v13, v21
    v_mul_f32 v14, 0xbfb8aa3b, v14
    v_exp_f32 v14, v14
    s_nop 0
    v_add_f32 v14, 1.0, v14
    v_rcp_f32 v14, v14
    s_nop 0
    v_mul_f32 v14, v14, v22
    v_mul_f32 v15, 0xbfb8aa3b, v15
    v_exp_f32 v15, v15
    s_nop 0
    v_add_f32 v15, 1.0, v15
    v_rcp_f32 v15, v15
    s_nop 0
    v_mul_f32 v15, v15, v23
    v_cvt_pk_bf16_f32 v40, v8, v9
    v_cvt_pk_bf16_f32 v41, v10, v11
    v_cvt_pk_bf16_f32 v42, v12, v13
    v_cvt_pk_bf16_f32 v43, v14, v15
    v_and_b32 v44, v40, v142
    v_and_b32 v45, v41, v142
    v_and_b32 v46, v42, v142
    v_and_b32 v47, v43, v142
    v_and_b32 v48, v40, v143
    v_and_b32 v49, v41, v143
    v_and_b32 v50, v42, v143
    v_and_b32 v51, v43, v143
    s_waitcnt lgkmcnt(0)
    s_nop 0
    v_mfma_f32_16x16x32_bf16 v[8:11], v[64:67], v[44:47], 0
    v_mfma_f32_16x16x32_bf16 v[12:15], v[68:71], v[44:47], 0
    v_mfma_f32_16x16x32_bf16 v[16:19], v[72:75], v[44:47], 0
    v_mfma_f32_16x16x32_bf16 v[20:23], v[76:79], v[44:47], 0
    v_mfma_f32_16x16x32_bf16 v[8:11], v[80:83], v[48:51], v[8:11]
    v_mfma_f32_16x16x32_bf16 v[12:15], v[84:87], v[48:51], v[12:15]
    v_mfma_f32_16x16x32_bf16 v[16:19], v[88:91], v[48:51], v[16:19]
    v_mfma_f32_16x16x32_bf16 v[20:23], v[92:95], v[48:51], v[20:23]
    v_and_b32 v4, 1, v1
    v_lshlrev_b32 v4, 8, v4
    v_lshl_add_u32 v4, v5, 4, v4
    s_nop 7
    v_add_f32_dpp v8, v8, v8 quad_perm:[2,3,0,1] row_mask:0xf bank_mask:0xf
    v_add_f32_dpp v9, v9, v9 quad_perm:[2,3,0,1] row_mask:0xf bank_mask:0xf
    v_add_f32_dpp v10, v10, v10 quad_perm:[2,3,0,1] row_mask:0xf bank_mask:0xf
    v_add_f32_dpp v11, v11, v11 quad_perm:[2,3,0,1] row_mask:0xf bank_mask:0xf
    v_add_f32_dpp v12, v12, v12 quad_perm:[2,3,0,1] row_mask:0xf bank_mask:0xf
    v_add_f32_dpp v13, v13, v13 quad_perm:[2,3,0,1] row_mask:0xf bank_mask:0xf
    v_add_f32_dpp v14, v14, v14 quad_perm:[2,3,0,1] row_mask:0xf bank_mask:0xf
    v_add_f32_dpp v15, v15, v15 quad_perm:[2,3,0,1] row_mask:0xf bank_mask:0xf
    v_add_f32_dpp v16, v16, v16 quad_perm:[2,3,0,1] row_mask:0xf bank_mask:0xf
    v_add_f32_dpp v17, v17, v17 quad_perm:[2,3,0,1] row_mask:0xf bank_mask:0xf
    v_add_f32_dpp v18, v18, v18 quad_perm:[2,3,0,1] row_mask:0xf bank_mask:0xf
    v_add_f32_dpp v19, v19, v19 quad_perm:[2,3,0,1] row_mask:0xf bank_mask:0xf
    v_add_f32_dpp v20, v20, v20 quad_perm:[2,3,0,1] row_mask:0xf bank_mask:0xf
    v_add_f32_dpp v21, v21, v21 quad_perm:[2,3,0,1] row_mask:0xf bank_mask:0xf
    v_add_f32_dpp v22, v22, v22 quad_perm:[2,3,0,1] row_mask:0xf bank_mask:0xf
    v_add_f32_dpp v23, v23, v23 quad_perm:[2,3,0,1] row_mask:0xf bank_mask:0xf
    v_mul_f32 v8, v129, v8
    v_mul_f32 v9, v129, v9
    v_mul_f32 v10, v129, v10
    v_mul_f32 v11, v129, v11
    v_mul_f32 v12, v129, v12
    v_mul_f32 v13, v129, v13
    v_mul_f32 v14, v129, v14
    v_mul_f32 v15, v129, v15
    v_mul_f32 v16, v129, v16
    v_mul_f32 v17, v129, v17
    v_mul_f32 v18, v129, v18
    v_mul_f32 v19, v129, v19
    v_mul_f32 v20, v129, v20
    v_mul_f32 v21, v129, v21
    v_mul_f32 v22, v129, v22
    v_mul_f32 v23, v129, v23
    ds_write_b128 v4, v[8:11] offset:3328
    ds_write_b128 v4, v[12:15] offset:3392
    ds_write_b128 v4, v[16:19] offset:3456
    ds_write_b128 v4, v[20:23] offset:3520
L_glu_done:
    v_and_b32 v6, 3, v1
    v_lshlrev_b32 v6, 3, v6
    v_and_b32 v4, 32, v1
    v_add_u32 v6, v6, v4
    s_mov_b32 s11, 1600012
L_poll_st:
    s_sleep 16
    ds_read_b64 v[8:9], v6 offset:3072
    s_sub_u32 s11, s11, 1
    s_cbranch_scc1 L_st_ok
    s_waitcnt lgkmcnt(0)
    v_cmp_eq_u32 vcc, 0, v9
    s_cbranch_vccnz L_poll_st
L_st_ok:
    s_waitcnt lgkmcnt(0)
    v_max_f32_dpp v12, v8, v8 quad_perm:[1,0,3,2] row_mask:0xf bank_mask:0xf
    s_nop 1
    v_max_f32_dpp v12, v12, v12 quad_perm:[2,3,0,1] row_mask:0xf bank_mask:0xf
    v_sub_f32 v13, v8, v12
    v_mul_f32 v13, s43, v13
    v_exp_f32 v13, v13
    s_nop 0
    v_mul_f32 v13, v13, v9
    s_nop 1
    v_add_f32_dpp v13, v13, v13 quad_perm:[1,0,3,2] row_mask:0xf bank_mask:0xf
    s_nop 1
    v_add_f32_dpp v13, v13, v13 quad_perm:[2,3,0,1] row_mask:0xf bank_mask:0xf
    v_lshlrev_b32 v14, 8, v12
    v_lshlrev_b32 v15, 8, v13
    v_bfi_b32 v12, v140, s68, v12
    v_bfi_b32 v13, v140, s69, v13
    v_bfi_b32 v14, v140, s70, v14
    v_bfi_b32 v15, v140, s71, v15
    s_lshl_b32 s12, s6, 10
    s_add_u32 s12, s12, 4096
    s_lshl_b32 s13, s7, 4
    s_add_u32 s13, s13, s12
    v_lshlrev_b32 v4, 4, v4
    s_waitcnt vmcnt(0)
    s_mov_b32 exec_lo, 1
    s_mov_b32 exec_hi, 1
    s_cmp_lg_u32 s15, 0
    s_cbranch_scc1 L_ms5
    buffer_store_dwordx4 v[12:15], v4, s[56:59], s13 offen
    s_branch L_mx5
L_ms5:
    buffer_store_dwordx4 v[12:15], v4, s[56:59], s13 offen sc1
L_mx5:
    s_mov_b64 exec, -1
    s_lshl_b32 s13, s8, 4
    v_xor_b32 v7, s13, v1
    v_lshl_add_u32 v7, v7, 4, s12
    s_mov_b32 s11, 400003
L_poll_sg:
    s_sleep 32
    s_bfe_u32 s76, s11, 0x10002
    s_or_b32 s76, s76, s15
    s_cbranch_scc1 L_ml6
    buffer_load_dwordx4 v[16:19], v7, s[56:59], 0 offen nt
    s_branch L_mlx6
L_ml6:
    buffer_load_dwordx4 v[16:19], v7, s[56:59], 0 offen sc1
L_mlx6:
    s_sub_u32 s11, s11, 1
    s_cbranch_scc1 L_sg_ok
    s_waitcnt vmcnt(0)
    v_perm_b32 v133, v17, v16, s42
    v_perm_b32 v134, v19, v18, s45
    v_or_b32 v133, v133, v134
    v_xor_b32 v135, s46, v133
    v_cmp_ne_u32 vcc, 0, v135
    s_cbranch_vccnz L_poll_sg
L_sg_ok:
    s_waitcnt vmcnt(0)
    v_lshrrev_b32 v18, 8, v18
    v_bfi_b32 v16, v140, v18, v16
    v_lshrrev_b32 v19, 8, v19
    v_bfi_b32 v17, v140, v19, v17
    v_lshrrev_b32 v6, 1, v6
    v_max_f32_dpp v20, v16, v16 row_ror:8 row_mask:0xf bank_mask:0xf
    s_nop 1
    v_max_f32_dpp v20, v20, v20 row_ror:4 row_mask:0xf bank_mask:0xf
    s_nop 1
    v_max_f32_dpp v20, v20, v20 row_ror:2 row_mask:0xf bank_mask:0xf
    s_nop 1
    v_max_f32_dpp v20, v20, v20 row_ror:1 row_mask:0xf bank_mask:0xf
    v_sub_f32 v21, v16, v20
    v_mul_f32 v21, s43, v21
    v_exp_f32 v21, v21
    s_nop 0
    v_mul_f32 v21, v21, v17
    s_nop 1
    v_add_f32_dpp v21, v21, v21 row_ror:8 row_mask:0xf bank_mask:0xf
    s_nop 1
    v_add_f32_dpp v21, v21, v21 row_ror:4 row_mask:0xf bank_mask:0xf
    s_nop 1
    v_add_f32_dpp v21, v21, v21 row_ror:2 row_mask:0xf bank_mask:0xf
    s_nop 1
    v_add_f32_dpp v21, v21, v21 row_ror:1 row_mask:0xf bank_mask:0xf
    v_rcp_f32 v21, v21
    v_sub_f32 v22, v8, v20
    v_mul_f32 v22, s43, v22
    v_exp_f32 v22, v22
    s_nop 0
    v_mul_f32 v22, v22, v21
    v_mul_f32 v22, s73, v22
    s_mov_b32 exec_lo, 15
    s_mov_b32 exec_hi, 15
    ds_write_b32 v6, v22 offset:3200
    s_mov_b64 exec, -1
    v_mov_b32 v7, 1024
    s_load_dword s11, s[40:41], 1536
    s_waitcnt lgkmcnt(0)
    s_cmp_eq_u32 s11, s46
    s_cbranch_scc1 L_af_ok
    s_mov_b32 s11, 400003
L_poll_af:
    s_sleep 1
    buffer_load_dwordx4 v[16:19], v7, s[56:59], 0 offen sc1
    s_sub_u32 s11, s11, 1
    s_cbranch_scc1 L_af_ok
    s_waitcnt vmcnt(0)
    v_perm_b32 v133, v17, v16, s42
    v_perm_b32 v134, v19, v18, s45
    v_or_b32 v133, v133, v134
    v_xor_b32 v135, s46, v133
    v_cmp_ne_u32 vcc, 0, v135
    s_cbranch_vccnz L_poll_af
L_af_ok:
    s_waitcnt vmcnt(0)
    v_mov_b32 v8, -1
    v_mov_b32 v9, -1
    v_lshlrev_b32 v4, 3, v1
    ds_write_b64 v4, v[8:9] offset:5120
    s_waitcnt lgkmcnt(0)
L_service_done:
    s_endpgm
L_control:
    v_mov_b32 v8, 0
    v_mov_b32 v9, 0
    v_mov_b32 v10, 0
    v_mov_b32 v11, 0
    v_lshlrev_b32 v5, 4, v1
    ds_write_b128 v5, v[8:11] offset:3072
    s_lshl_b32 s11, s6, 8
    s_add_u32 s11, s11, 12288
    s_lshl_b32 s12, s7, 2
    s_add_u32 s12, s12, s11
    v_mov_b32 v4, s12
    v_min_u32 v5, 32, v1
    v_lshl_add_u32 v5, v5, 2, s11
    s_add_u32 s12, s11, 128
    v_mov_b32 v12, s12
    v_and_b32 v2, 3, v1
    v_lshlrev_b32 v2, 2, v2
    v_mov_b32 v7, 80
    s_waitcnt lgkmcnt(0)
    s_mov_b32 s56, s40
    s_and_b32 s57, s41, 0xffff
    s_mov_b32 s58, 925696
    s_mov_b32 s59, 0x20000
    s_mov_b32 s44, s24
    s_and_b32 s45, s25, 0xffff
    s_mov_b32 s46, 3670016
    s_mov_b32 s47, 0x20000
    s_lshl_b32 s11, s6, 2
    s_add_u32 s11, s11, s9
    s_mul_i32 s11, s11, 114688
    s_lshl_b32 s12, s10, 7
    s_add_u32 s11, s11, s12
    v_lshrrev_b32 v15, 3, v1
    v_mul_u32_u24 v14, 896, v15
    v_and_b32 v15, 7, v1
    v_lshl_add_u32 v14, v15, 4, v14
    v_add_u32 v14, s11, v14
    s_barrier
    s_getpc_b64 s[48:49]
L_pc:
    s_sub_u32 s48, s48, L_pc-gated_mix__gqa_block_cached__glu_gated_glu__decode_kernel
    s_subb_u32 s49, s49, 0
    s_lshl_b32 s12, s7, 10
    v_lshl_add_u32 v24, v1, 4, s12
    v_mov_b32 v27, s49
    v_add_co_u32 v26, vcc, s48, v24
    s_nop 1
    v_addc_co_u32 v27, vcc, 0, v27, vcc
    s_mov_b32 s12, L_end-gated_mix__gqa_block_cached__glu_gated_glu__decode_kernel-16
    v_cmp_ge_u32 vcc, s12, v24
    s_and_b64 exec, exec, vcc
    s_cbranch_execz L_pc_skip
    global_load_dwordx4 v[28:31], v[26:27], off
L_pc_skip:
    s_mov_b64 exec, -1
    s_lshl_b32 s12, s6, 5
    s_add_u32 s12, s12, s7
    s_lshl_b32 s12, s12, 9
    s_add_u32 s12, s12, 131072
    s_load_dword s60, s[40:41], s12
    s_add_u32 s12, s12, 64
    s_load_dword s61, s[40:41], s12
    s_add_u32 s12, s12, 64
    s_load_dword s62, s[40:41], s12
    s_add_u32 s12, s12, 64
    s_load_dword s63, s[40:41], s12
    s_add_u32 s12, s12, 64
    s_load_dword s64, s[40:41], s12
    s_add_u32 s12, s12, 64
    s_load_dword s65, s[40:41], s12
    s_add_u32 s12, s12, 64
    s_load_dword s66, s[40:41], s12
    s_add_u32 s12, s12, 64
    s_load_dword s67, s[40:41], s12
    s_add_u32 s12, s12, 64
    s_lshl_b32 s12, s6, 4
    s_add_u32 s12, s12, s5
    s_lshl_b32 s12, s12, 6
    s_add_u32 s12, s12, 4096
    s_load_dword s68, s[40:41], s12
    s_waitcnt lgkmcnt(0)
    s_mov_b32 s11, 3200024
L_c_wait:
    s_sleep 2
    ds_read_b96 v[16:18], v9 offset:3264
    ds_read_b128 v[20:23], v9 offset:3296
    s_sub_u32 s11, s11, 1
    s_cbranch_scc1 L_c_exit
    s_waitcnt lgkmcnt(0)
    v_lshlrev_b32 v18, 1, v18
    v_min3_u32 v18, v18, v20, v21
    v_min3_u32 v18, v18, v22, v23
    v_cmp_gt_u32 vcc, 2, v18
    s_cbranch_vccnz L_c_wait
    v_cmp_ne_u32 vcc, 0, v16
    s_cbranch_vccnz L_c_exit
    v_readfirstlane_b32 s43, v17
    s_mov_b32 s61, 6144
    s_mov_b32 s65, 1536
    s_mov_b32 s67, 0
    s_mov_b32 s68, 0
    s_mov_b32 s69, 0
    s_mov_b32 s70, 0
    s_mov_b32 s74, 0
    s_mov_b32 s11, 400003
L_c_loop:
    ds_read_b32 v6, v2 offset:3296
    s_waitcnt lgkmcnt(0)
    v_add_u32_dpp v7, v6, v6 quad_perm:[1,0,3,2] row_mask:0xf bank_mask:0xf
    s_nop 1
    v_add_u32_dpp v7, v7, v7 quad_perm:[2,3,0,1] row_mask:0xf bank_mask:0xf
    s_nop 0
    v_readfirstlane_b32 s12, v7
    s_sub_u32 s75, s12, s74
    s_cmp_ge_i32 s75, 968
    s_cbranch_scc1 L_c_last
    s_cmp_ge_u32 s12, 984
    s_cbranch_scc1 L_c_last
    s_cmp_lg_u32 s7, 31
    s_cbranch_scc1 L_c_n0
    s_load_dword s70, s[40:41], s65 glc
L_c_n0:
    buffer_load_dword v8, v5, s[56:59], 0 offen nt
    s_mov_b64 exec, 1
    buffer_store_dword v7, v4, s[56:59], 0 offen
    s_mov_b64 exec, -1
    s_waitcnt vmcnt(1)
    v_readlane_b32 s13, v8, s7
    v_readlane_b32 s64, v8, 32
    v_add_u32_dpp v8, v8, v8 row_ror:8 row_mask:0xf bank_mask:0xf
    s_nop 1
    v_add_u32_dpp v8, v8, v8 row_ror:4 row_mask:0xf bank_mask:0xf
    s_nop 1
    v_add_u32_dpp v8, v8, v8 row_ror:2 row_mask:0xf bank_mask:0xf
    s_nop 1
    v_add_u32_dpp v8, v8, v8 row_ror:1 row_mask:0xf bank_mask:0xf
    s_nop 1
    v_readlane_b32 s62, v8, 0
    v_readlane_b32 s63, v8, 16
    ds_read_b32 v6, v2 offset:3296
    s_add_u32 s62, s62, s63
    s_add_u32 s13, s13, s12
    s_lshl_b32 s13, s13, 4
    s_sub_u32 s13, s13, s62
    s_lshl_b32 s75, s64, 3
    s_add_u32 s75, s75, s13
    s_ashr_i32 s75, s75, 5
    s_add_u32 s74, s74, s75
    s_ashr_i32 s74, s74, 1
    s_add_u32 s13, s13, s64
    s_add_u32 s13, s13, 256
    v_mov_b32 v8, s13
    s_waitcnt lgkmcnt(0)
    v_add_u32_dpp v7, v6, v6 quad_perm:[1,0,3,2] row_mask:0xf bank_mask:0xf
    s_nop 1
    v_add_u32_dpp v7, v7, v7 quad_perm:[2,3,0,1] row_mask:0xf bank_mask:0xf
    v_lshlrev_b32 v6, 2, v6
    v_sub_u32 v6, v6, v7
    v_lshl_add_u32 v8, v6, 5, v8
    v_lshrrev_b32 v8, 31, v8
    ds_write_b32 v2, v8 offset:3312
    s_cmp_lg_u32 s7, 31
    s_cbranch_scc1 L_c_norep
    s_cmp_ge_u32 s65, 786432
    s_cbranch_scc1 L_c_armed
    s_cmp_eq_u32 s70, s43
    s_cselect_b32 s65, 786432, s65
    s_branch L_c_norep
L_c_armed:
    s_sub_u32 s71, s62, s61
    s_cmp_lg_u32 s67, 0
    s_cbranch_scc1 L_c_posted
    s_cmp_lt_i32 s71, 0
    s_cbranch_scc1 L_c_posted
    s_add_u32 s66, s71, 16777216
    v_mov_b32 v11, s66
    s_mov_b64 exec, 1
    buffer_atomic_add v11, v9, s[56:59], s65 offen
    s_mov_b64 exec, -1
    s_mov_b32 s67, 1
L_c_posted:
    s_lshr_b32 s72, s70, 24
    s_sub_u32 s73, s72, s69
    s_mov_b32 s69, s72
    s_mul_i32 s73, s73, s71
    s_add_u32 s68, s68, s73
    s_cmp_lg_u32 s72, 8
    s_cbranch_scc1 L_c_norep
    s_cmp_ge_u32 s65, 851712
    s_cbranch_scc1 L_c_norep
    s_and_b32 s73, s70, 0xffffff
    s_sub_u32 s68, s68, s73
    s_ashr_i32 s68, s68, 3
    s_sub_u32 s68, s68, 950
    s_ashr_i32 s68, s68, 2
    v_mov_b32 v10, s68
    s_mov_b64 exec, 1
    buffer_store_dword v10, v12, s[56:59], 0 offen
    s_mov_b64 exec, -1
    s_add_u32 s61, s61, 2048
    s_add_u32 s65, s65, 4352
    s_mov_b32 s67, 0
    s_mov_b32 s68, 0
    s_mov_b32 s69, 0
L_c_norep:
    s_sub_u32 s11, s11, 1
    s_cbranch_scc0 L_c_loop
L_c_last:
    s_add_u32 s74, s74, 1008
    s_min_i32 s74, s74, 1016
    v_add_u32 v7, 20, v7
    s_mov_b64 exec, 1
    buffer_store_dword v7, v4, s[56:59], 0 offen
    s_mov_b64 exec, -1
    s_mov_b32 s11, 12800096
L_c_tight:
    ds_read_b128 v[20:23], v9 offset:3296
    s_sub_u32 s11, s11, 1
    s_cbranch_scc1 L_c_exit
    s_waitcnt lgkmcnt(0)
    v_add3_u32 v20, v20, v21, v22
    v_add_u32 v20, v20, v23
    v_cmp_gt_i32 vcc, s74, v20
    s_cbranch_vccnz L_c_tight
L_c_exit:
    v_mov_b32 v8, 2
    ds_write_b32 v2, v8 offset:3312
    s_cmp_ge_u32 s7, 28
    s_cbranch_scc1 L_c_done
    s_mov_b32 s11, 12800096
L_c_tight2:
    ds_read_b128 v[20:23], v9 offset:3296
    s_sub_u32 s11, s11, 1
    s_cbranch_scc1 L_c_wo
    s_waitcnt lgkmcnt(0)
    v_add3_u32 v20, v20, v21, v22
    v_add_u32 v20, v20, v23
    v_cmp_gt_u32 vcc, 1024, v20
    s_cbranch_vccnz L_c_tight2
L_c_wo:
    s_mov_b32 m0, 49152
    s_mov_b32 s42, 0
    buffer_load_dwordx4 v14, s[44:47], s42 offen nt lds
    s_mov_b32 m0, 50176
    s_mov_b32 s42, 7168
    buffer_load_dwordx4 v14, s[44:47], s42 offen nt lds
    s_mov_b32 m0, 51200
    s_mov_b32 s42, 14336
    buffer_load_dwordx4 v14, s[44:47], s42 offen nt lds
    s_mov_b32 m0, 52224
    s_mov_b32 s42, 21504
    buffer_load_dwordx4 v14, s[44:47], s42 offen nt lds
    s_mov_b32 m0, 53248
    s_mov_b32 s42, 28672
    buffer_load_dwordx4 v14, s[44:47], s42 offen nt lds
    s_mov_b32 m0, 54272
    s_mov_b32 s42, 35840
    buffer_load_dwordx4 v14, s[44:47], s42 offen nt lds
    s_mov_b32 m0, 55296
    s_mov_b32 s42, 43008
    buffer_load_dwordx4 v14, s[44:47], s42 offen nt lds
    s_mov_b32 m0, 56320
    s_mov_b32 s42, 50176
    buffer_load_dwordx4 v14, s[44:47], s42 offen nt lds
    s_mov_b32 m0, 57344
    s_mov_b32 s42, 57344
    buffer_load_dwordx4 v14, s[44:47], s42 offen nt lds
    s_mov_b32 m0, 58368
    s_mov_b32 s42, 64512
    buffer_load_dwordx4 v14, s[44:47], s42 offen nt lds
    s_mov_b32 m0, 59392
    s_mov_b32 s42, 71680
    buffer_load_dwordx4 v14, s[44:47], s42 offen nt lds
    s_mov_b32 m0, 60416
    s_mov_b32 s42, 78848
    buffer_load_dwordx4 v14, s[44:47], s42 offen nt lds
    s_mov_b32 m0, 61440
    s_mov_b32 s42, 86016
    buffer_load_dwordx4 v14, s[44:47], s42 offen nt lds
    s_mov_b32 m0, 62464
    s_mov_b32 s42, 93184
    buffer_load_dwordx4 v14, s[44:47], s42 offen nt lds
    s_mov_b32 m0, 63488
    s_mov_b32 s42, 100352
    buffer_load_dwordx4 v14, s[44:47], s42 offen nt lds
    s_mov_b32 m0, 64512
    s_mov_b32 s42, 107520
    buffer_load_dwordx4 v14, s[44:47], s42 offen nt lds
    s_barrier
    s_waitcnt vmcnt(0)
    ds_write_b32 v9, v8 offset:3280
L_c_done:
    s_endpgm
L_end:
    s_endpgm
.section .rodata,"a"
.p2align 6
.amdhsa_kernel gated_mix__gqa_block_cached__glu_gated_glu__decode_kernel
  .amdhsa_next_free_vgpr 256
  .amdhsa_next_free_sgpr 102
  .amdhsa_accum_offset 256
  .amdhsa_group_segment_fixed_size 0
  .amdhsa_kernarg_size 104
  .amdhsa_user_sgpr_count 2
  .amdhsa_user_sgpr_kernarg_segment_ptr 1
  .amdhsa_system_sgpr_workgroup_id_x 1
  .amdhsa_float_denorm_mode_32 3
.end_amdhsa_kernel
```
